```python
import torch

def _softmax(x, axis=-1):
    return torch.softmax(x, dim=axis)
def _gelu(x):
    return torch.nn.functional.gelu(x, approximate="tanh")
def _silu(x):
    return torch.nn.functional.silu(x)
def _sigmoid(x):
    return torch.sigmoid(x)
def _layernorm(x, axis=-1, eps=1e-5):
    m = x.mean(dim=axis, keepdim=True)
    v = x.var(dim=axis, keepdim=True, unbiased=False)
    return (x - m) / torch.sqrt(v + eps)
def _scatter_add(tgt, idx, src, axis=0):
    return tgt.clone().index_add_(axis, idx, src)
def _segment_sum(src, seg, n):
    out = torch.zeros((n,) + src.shape[1:], dtype=src.dtype)
    return out.index_add_(0, seg, src)
def _pad(x, pw):
    flat = tuple(v for pair in reversed(pw) for v in pair)
    return torch.nn.functional.pad(x, flat)

kernel_name = 'standalone__edm_precond__diffusion'

def setup_inputs():

    _w = (lambda a: (lambda t: t.to(torch.bfloat16) if t.is_floating_point() else t)(torch.as_tensor(a)))
    B, C, HW = 2, 320, 128
    return {
        "x": _w((lambda *s: torch.randn(*s, dtype=torch.bfloat16) * 0.2)(B, C, HW, HW)),
        "sigma": _w((lambda _x: torch.exp(torch.as_tensor(_x)))((lambda *s: torch.randn(*s, dtype=torch.bfloat16) * 3.2)(B))),
        "w_in": _w((lambda *s: torch.randn(*s, dtype=torch.bfloat16) * 3.2)(C, C) * (C ** -0.5)),
        "w_emb": _w((lambda *s: torch.randn(*s, dtype=torch.bfloat16) * 3.2)(1, C)),
        "w_out": _w((lambda *s: torch.randn(*s, dtype=torch.bfloat16) * 3.2)(C, C) * (C ** -0.5)),
    }

def reference(x, sigma, w_in, w_emb, w_out):
    B, C, H, W = x.shape
    sigma_data = 0.5
    s = sigma.reshape(B, 1, 1, 1)
    denom = s * s + sigma_data * sigma_data
    c_skip = (sigma_data * sigma_data) / denom
    c_out  = s * sigma_data / torch.sqrt(denom)
    c_in   = 1.0 / torch.sqrt(denom)
    c_noise = 0.25 * torch.log(sigma).reshape(B, 1)
    h = torch.einsum("bchw,cd->bdhw", c_in * x, w_in)
    h = h + (c_noise @ w_emb).reshape(B, C, 1, 1)
    h = _silu(h)
    Fx = torch.einsum("bchw,cd->bdhw", h, w_out)
    return c_skip * x + c_out * Fx
```

```asm
; @launch grid=(256,1,1) block=(256,1,1) lds=163840
.amdgcn_target "amdgcn-amd-amdhsa--gfx950"
.text
.globl standalone__edm_precond__diffusion_kernel
.p2align 8
.type standalone__edm_precond__diffusion_kernel,@function
standalone__edm_precond__diffusion_kernel:
    s_load_dwordx8 s[4:11], s[0:1], 0
    s_load_dwordx4 s[12:15], s[0:1], 32
    s_cmp_ge_u32 s2, 256
    s_cbranch_scc1 L_end
L_pc:
    s_getpc_b64 s[50:51]
    v_lshlrev_b32 v49, 7, v0
    v_min_u32 v49, 20740, v49
    global_load_dword v95, v49, s[50:51]
    v_lshrrev_b32 v35, 6, v0
    v_and_b32 v90, 63, v0
    v_readfirstlane_b32 s36, v35
    v_lshrrev_b32 v29, 4, v90
    v_lshlrev_b32 v36, 4, v90
    v_and_b32 v37, 64, v0
    v_xor_b32 v36, v36, v37
    v_mul_u32_u24 v38, 2560, v35
    v_add_u32 v17, v36, v38
    v_xor_b32 v40, 32, v17
    v_cmp_gt_u32 vcc, 16, v90
    v_add_u32 v41, 48640, v17
    v_add_u32 v42, 48640, v40
    v_cndmask_b32 v18, v40, v17, vcc
    v_cmp_gt_u32 vcc, 32, v90
    v_add_u32 v21, 4096, v42
    v_bfe_u32 v45, v0, 3, 2
    v_cndmask_b32 v19, v41, v40, vcc
    v_cmp_gt_u32 vcc, 48, v90
    v_lshrrev_b32 v44, 5, v90
    v_lshl_add_u32 v46, v35, 2, v45
    v_cndmask_b32 v20, v42, v41, vcc
    v_mad_u32_u24 v44, v44, 40, 0
    v_lshl_add_u32 v44, v44, 1, v46
    v_and_b32 v46, 0x70, v36
    v_and_b32 v47, 16, v90
    v_lshlrev_b32 v47, 1, v47
    v_xor_b32 v46, v46, v47
    v_lshl_add_u32 v22, v44, 15, v46
    s_mul_i32 s42, s36, 5120
    s_add_u32 s42, s42, 81920
    s_lshl_b32 s43, s36, 10
    v_mul_u32_u24 v48, 160, v35
    v_lshl_add_u32 v48, v29, 3, v48
    s_lshr_b32 s53, s2, 7
    s_mul_i32 s54, s53, 10485760
    s_and_b32 s55, s2, 127
    s_lshl_b32 s55, s55, 8
    s_add_u32 s54, s54, s55
    s_sub_u32 s18, 20971520, s54
    s_mov_b32 s35, 0x20000
    s_mov_b32 s23, 0x20000
    s_mov_b32 s19, 0x20000
    s_movk_i32 s34, 640
    s_mov_b32 s22, 204800
    s_bfe_u32 s46, s2, 0x50003
    s_mul_i32 s46, s46, 6400
    v_mad_u32_u24 v31, v35, 13, v90
    v_lshlrev_b32 v31, 7, v31
    v_cmp_gt_u32 vcc, 13, v90
    v_add_u32 v31, s46, v31
    v_mov_b32 v50, 0x7fffff00
    v_cndmask_b32 v31, v50, v31, vcc
    s_waitcnt lgkmcnt(0)
    s_load_dword s47, s[6:7], 0
    s_add_u32 s16, s4, s54
    s_addc_u32 s17, s5, 0
    s_mov_b64 s[20:21], s[8:9]
    s_mov_b64 s[32:33], s[10:11]
    s_add_u32 m0, s43, 0
    s_mov_b32 s49, 0
    buffer_load_dwordx4 v22, s[16:19], s49 offen nt lds
    s_add_u32 m0, s43, 40960
    s_mov_b32 s49, 128
    buffer_load_dwordx4 v22, s[16:19], s49 offen nt lds
    s_add_u32 m0, s42, 0
    s_mov_b32 s48, 0
    buffer_load_dwordx4 v17, s[20:23], s48 offen lds
    buffer_load_dwordx4 v18, s[20:23], s48 offen offset:1024 lds
    buffer_load_dwordx4 v19, s[20:23], s48 offen offset:2048 lds
    buffer_load_dwordx4 v20, s[20:23], s48 offen offset:3072 lds
    s_add_u32 m0, s42, 4096
    s_nop 0
    buffer_load_dwordx4 v21, s[20:23], s48 offen lds
    s_add_u32 m0, s43, 4096
    s_mov_b32 s49, 5242880
    buffer_load_dwordx4 v22, s[16:19], s49 offen nt lds
    s_add_u32 m0, s43, 45056
    s_mov_b32 s49, 5243008
    buffer_load_dwordx4 v22, s[16:19], s49 offen nt lds
    buffer_load_dwordx2 v[56:57], v48, s[32:35], 0 offen offset:0
    buffer_load_dwordx2 v[60:61], v48, s[32:35], 0 offen offset:32
    buffer_load_dwordx2 v[64:65], v48, s[32:35], 0 offen offset:64
    buffer_load_dwordx2 v[68:69], v48, s[32:35], 0 offen offset:96
    buffer_load_dwordx2 v[72:73], v48, s[32:35], 0 offen offset:128
    buffer_load_dword v94, v31, s[20:23], 0 offen
    s_mov_b64 s[24:25], s[12:13]
    s_add_u32 s28, s14, s54
    s_addc_u32 s29, s15, 0
    s_mov_b32 s30, s18
    s_mov_b32 s26, 204800
    s_mov_b32 s27, 0x20000
    s_mov_b32 s31, 0x20000
    v_bfe_u32 v91, v90, 2, 2
    s_add_u32 m0, s42, 20480
    s_mov_b32 s48, 102400
    buffer_load_dwordx4 v17, s[20:23], s48 offen lds
    v_and_b32 v92, 3, v90
    v_and_b32 v30, 15, v90
    v_lshl_add_u32 v36, v29, 3, v91
    v_lshrrev_b32 v37, 1, v91
    v_and_b32 v38, 1, v29
    v_lshl_add_u32 v37, v38, 1, v37
    v_lshlrev_b32 v37, 5, v37
    v_mul_u32_u24 v39, 640, v36
    buffer_load_dwordx4 v18, s[20:23], s48 offen offset:1024 lds
    v_add_u32 v39, 81920, v39
    v_mul_u32_u24 v40, 160, v35
    v_lshl_add_u32 v40, v92, 3, v40
    v_add_u32 v41, 0, v40
    v_xad_u32 v1, v41, v37, v39
    v_add_u32 v41, 32, v40
    v_xad_u32 v2, v41, v37, v39
    v_add_u32 v41, 64, v40
    buffer_load_dwordx4 v19, s[20:23], s48 offen offset:2048 lds
    v_xad_u32 v3, v41, v37, v39
    v_add_u32 v41, 96, v40
    v_xad_u32 v4, v41, v37, v39
    v_add_u32 v41, 128, v40
    v_xad_u32 v5, v41, v37, v39
    v_lshlrev_b32 v40, 3, v92
    v_lshlrev_b32 v39, 7, v36
    v_add_u32 v41, 0, v40
    buffer_load_dwordx4 v20, s[20:23], s48 offen offset:3072 lds
    v_xad_u32 v6, v41, v37, v39
    v_add_u32 v41, 32, v40
    v_xad_u32 v7, v41, v37, v39
    v_add_u32 v41, 64, v40
    v_xad_u32 v8, v41, v37, v39
    v_add_u32 v41, 96, v40
    v_xad_u32 v9, v41, v37, v39
    v_lshrrev_b32 v42, 1, v35
    s_add_u32 m0, s42, 24576
    s_nop 0
    buffer_load_dwordx4 v21, s[20:23], s48 offen lds
    v_lshlrev_b32 v42, 12, v42
    v_and_b32 v43, 1, v35
    v_lshl_add_u32 v44, v43, 9, v42
    v_add_u32 v44, v39, v44
    v_lshlrev_b32 v40, 4, v92
    v_add_u32 v41, 0, v40
    v_xad_u32 v10, v41, v37, v44
    v_add_u32 v41, 8, v40
    s_add_u32 m0, s43, 8192
    s_mov_b32 s49, 524288
    buffer_load_dwordx4 v22, s[16:19], s49 offen nt lds
    v_xad_u32 v11, v41, v37, v44
    v_add_u32 v41, 64, v40
    v_xad_u32 v12, v41, v37, v44
    v_add_u32 v41, 72, v40
    v_xad_u32 v13, v41, v37, v44
    v_lshl_add_u32 v40, v91, 3, v92
    v_lshlrev_b32 v41, 2, v38
    v_xor_b32 v40, v40, v41
    s_add_u32 m0, s43, 49152
    s_mov_b32 s49, 524416
    buffer_load_dwordx4 v22, s[16:19], s49 offen nt lds
    v_lshlrev_b32 v40, 4, v40
    v_lshl_add_u32 v14, v29, 10, v40
    v_xor_b32 v15, 64, v14
    v_xor_b32 v40, v30, v41
    v_lshl_add_u32 v40, v40, 4, v42
    v_lshl_add_u32 v40, v29, 10, v40
    v_lshl_add_u32 v16, v43, 3, v40
    v_add_u32 v28, 81920, v16
    v_mul_u32_u24 v40, 80, v35
    v_add_u32 v40, v40, v30
    v_lshlrev_b32 v41, 4, v29
    v_lshl_add_u32 v23, v40, 15, v41
    s_waitcnt vmcnt(15)
    s_barrier
    ds_read_b64_tr_b16 a[140:141], v1 offset:0
    ds_read_b64_tr_b16 a[142:143], v1 offset:2560
    ds_read_b64_tr_b16 a[144:145], v2 offset:0
    ds_read_b64_tr_b16 a[146:147], v2 offset:2560
    ds_read_b64_tr_b16 a[148:149], v3 offset:0
    ds_read_b64_tr_b16 a[150:151], v3 offset:2560
    ds_read_b64_tr_b16 a[152:153], v4 offset:0
    ds_read_b64_tr_b16 a[154:155], v4 offset:2560
    ds_read_b64_tr_b16 a[156:157], v5 offset:0
    ds_read_b64_tr_b16 a[158:159], v5 offset:2560
    ds_read_b64_tr_b16 a[200:201], v6 offset:0
    ds_read_b64_tr_b16 a[202:203], v6 offset:512
    ds_read_b64_tr_b16 a[204:205], v7 offset:0
    ds_read_b64_tr_b16 a[206:207], v7 offset:512
    ds_read_b64_tr_b16 a[208:209], v8 offset:0
    ds_read_b64_tr_b16 a[210:211], v8 offset:512
    ds_read_b64_tr_b16 a[212:213], v9 offset:0
    ds_read_b64_tr_b16 a[214:215], v9 offset:512
    ds_read_b64_tr_b16 a[216:217], v6 offset:40960
    ds_read_b64_tr_b16 a[218:219], v6 offset:41472
    s_waitcnt lgkmcnt(0)
    v_mfma_f32_16x16x32_bf16 v[96:99], a[140:143], a[200:203], 0
    s_add_u32 m0, s42, 40960
    v_mfma_f32_16x16x32_bf16 v[104:107], a[144:147], a[200:203], 0
    s_mov_b32 s48, 10240
    buffer_load_dwordx4 v17, s[20:23], s48 offen lds
    v_mfma_f32_16x16x32_bf16 v[112:115], a[148:151], a[200:203], 0
    ds_read_b64_tr_b16 a[220:221], v7 offset:40960
    v_mfma_f32_16x16x32_bf16 v[120:123], a[152:155], a[200:203], 0
    ds_read_b64_tr_b16 a[222:223], v7 offset:41472
    v_mfma_f32_16x16x32_bf16 v[128:131], a[156:159], a[200:203], 0
    v_mfma_f32_16x16x32_bf16 v[100:103], a[140:143], a[204:207], 0
    buffer_load_dwordx4 v18, s[20:23], s48 offen offset:1024 lds
    v_mfma_f32_16x16x32_bf16 v[108:111], a[144:147], a[204:207], 0
    ds_read_b64_tr_b16 a[224:225], v8 offset:40960
    v_mfma_f32_16x16x32_bf16 v[116:119], a[148:151], a[204:207], 0
    ds_read_b64_tr_b16 a[226:227], v8 offset:41472
    v_mfma_f32_16x16x32_bf16 v[124:127], a[152:155], a[204:207], 0
    v_mfma_f32_16x16x32_bf16 v[132:135], a[156:159], a[204:207], 0
    buffer_load_dwordx4 v19, s[20:23], s48 offen offset:2048 lds
    v_mfma_f32_16x16x32_bf16 v[136:139], a[140:143], a[208:211], 0
    v_mfma_f32_16x16x32_bf16 v[144:147], a[144:147], a[208:211], 0
    ds_read_b64_tr_b16 a[228:229], v9 offset:40960
    v_mfma_f32_16x16x32_bf16 v[152:155], a[148:151], a[208:211], 0
    ds_read_b64_tr_b16 a[230:231], v9 offset:41472
    v_mfma_f32_16x16x32_bf16 v[160:163], a[152:155], a[208:211], 0
    s_waitcnt vmcnt(5) lgkmcnt(0)
    buffer_load_dwordx4 v20, s[20:23], s48 offen offset:3072 lds
    v_mfma_f32_16x16x32_bf16 v[168:171], a[156:159], a[208:211], 0
    s_barrier
    s_lshl_b32 s51, s47, 16
    s_and_b32 s52, s47, 0xffff0000
    s_cmp_eq_u32 s53, 0
    s_cselect_b32 s47, s51, s52
    v_mfma_f32_16x16x32_bf16 v[140:143], a[140:143], a[212:215], 0
    ds_read_b64_tr_b16 a[120:121], v1 offset:20480
    v_mfma_f32_16x16x32_bf16 v[148:151], a[144:147], a[212:215], 0
    s_add_u32 m0, s42, 45056
    ds_read_b64_tr_b16 a[122:123], v1 offset:23040
    v_mfma_f32_16x16x32_bf16 v[156:159], a[148:151], a[212:215], 0
    buffer_load_dwordx4 v21, s[20:23], s48 offen lds
    v_mfma_f32_16x16x32_bf16 v[164:167], a[152:155], a[212:215], 0
    ds_read_b64_tr_b16 a[124:125], v2 offset:20480
    v_mfma_f32_16x16x32_bf16 v[172:175], a[156:159], a[212:215], 0
    ds_read_b64_tr_b16 a[126:127], v2 offset:23040
    v_mfma_f32_16x16x32_bf16 v[176:179], a[140:143], a[216:219], 0
    s_add_u32 m0, s42, 61440
    ds_read_b64_tr_b16 a[128:129], v3 offset:20480
    v_mfma_f32_16x16x32_bf16 v[184:187], a[144:147], a[216:219], 0
    s_mov_b32 s48, 112640
    buffer_load_dwordx4 v17, s[20:23], s48 offen lds
    v_mfma_f32_16x16x32_bf16 v[192:195], a[148:151], a[216:219], 0
    ds_read_b64_tr_b16 a[130:131], v3 offset:23040
    v_mov_b32 v80, s47
    v_and_b32 v92, 1, v30
    v_mfma_f32_16x16x32_bf16 v[200:203], a[152:155], a[216:219], 0
    ds_read_b64_tr_b16 a[132:133], v4 offset:20480
    v_mul_f32 v81, v80, v80
    v_mul_f32 v85, 0.5, v80
    v_mfma_f32_16x16x32_bf16 v[208:211], a[156:159], a[216:219], 0
    ds_read_b64_tr_b16 a[134:135], v4 offset:23040
    v_mfma_f32_16x16x32_bf16 v[180:183], a[140:143], a[220:223], 0
    buffer_load_dwordx4 v18, s[20:23], s48 offen offset:1024 lds
    v_mfma_f32_16x16x32_bf16 v[188:191], a[144:147], a[220:223], 0
    ds_read_b64_tr_b16 a[136:137], v5 offset:20480
    v_cvt_pk_bf16_f32 v81, v81, v81
    v_lshlrev_b32 v92, 4, v92
    v_mfma_f32_16x16x32_bf16 v[196:199], a[148:151], a[220:223], 0
    ds_read_b64_tr_b16 a[138:139], v5 offset:23040
    v_lshlrev_b32 v81, 16, v81
    v_sub_u32 v92, 16, v92
    v_mfma_f32_16x16x32_bf16 v[204:207], a[152:155], a[220:223], 0
    ds_read_b64_tr_b16 a[232:233], v6 offset:4096
    v_mfma_f32_16x16x32_bf16 v[212:215], a[156:159], a[220:223], 0
    buffer_load_dwordx4 v19, s[20:23], s48 offen offset:2048 lds
    v_mfma_f32_16x16x32_bf16 v[216:219], a[140:143], a[224:227], 0
    ds_read_b64_tr_b16 a[234:235], v6 offset:4608
    v_log_f32 v86, v80
    v_mfma_f32_16x16x32_bf16 v[224:227], a[144:147], a[224:227], 0
    ds_read_b64_tr_b16 a[200:201], v7 offset:4096
    v_add_f32 v81, 0x3e800000, v81
    v_mul_f32 v86, 0x3f317218, v86
    v_mfma_f32_16x16x32_bf16 v[232:235], a[148:151], a[224:227], 0
    ds_read_b64_tr_b16 a[202:203], v7 offset:4608
    v_mfma_f32_16x16x32_bf16 v[240:243], a[152:155], a[224:227], 0
    s_waitcnt vmcnt(8) lgkmcnt(4)
    buffer_load_dwordx4 v20, s[20:23], s48 offen offset:3072 lds
    v_mfma_f32_16x16x32_bf16 v[248:251], a[156:159], a[224:227], 0
    s_barrier
    v_mfma_f32_16x16x32_bf16 v[220:223], a[140:143], a[228:231], 0
    ds_read_b64_tr_b16 a[204:205], v8 offset:4096
    v_mfma_f32_16x16x32_bf16 v[228:231], a[144:147], a[228:231], 0
    s_add_u32 m0, s42, 65536
    ds_read_b64_tr_b16 a[206:207], v8 offset:4608
    v_mfma_f32_16x16x32_bf16 v[236:239], a[148:151], a[228:231], 0
    buffer_load_dwordx4 v21, s[20:23], s48 offen lds
    v_mfma_f32_16x16x32_bf16 v[244:247], a[152:155], a[228:231], 0
    ds_read_b64_tr_b16 a[208:209], v9 offset:4096
    v_mfma_f32_16x16x32_bf16 v[252:255], a[156:159], a[228:231], 0
    s_waitcnt lgkmcnt(5)
    ds_read_b64_tr_b16 a[210:211], v9 offset:4608
    v_mfma_f32_16x16x32_bf16 v[96:99], a[120:123], a[232:235], v[96:99]
    s_add_u32 m0, s43, 12288
    ds_read_b64_tr_b16 a[212:213], v6 offset:45056
    v_mfma_f32_16x16x32_bf16 v[104:107], a[124:127], a[232:235], v[104:107]
    s_mov_b32 s49, 5767168
    buffer_load_dwordx4 v22, s[16:19], s49 offen nt lds
    v_mfma_f32_16x16x32_bf16 v[112:115], a[128:131], a[232:235], v[112:115]
    s_add_u32 m0, s43, 53248
    ds_read_b64_tr_b16 a[214:215], v6 offset:45568
    v_mfma_f32_16x16x32_bf16 v[120:123], a[132:135], a[232:235], v[120:123]
    s_mov_b32 s49, 5767296
    buffer_load_dwordx4 v22, s[16:19], s49 offen nt lds
    v_mfma_f32_16x16x32_bf16 v[128:131], a[136:139], a[232:235], v[128:131]
    s_waitcnt lgkmcnt(6)
    s_add_u32 m0, s43, 16384
    ds_read_b64_tr_b16 a[216:217], v7 offset:45056
    v_mfma_f32_16x16x32_bf16 v[100:103], a[120:123], a[200:203], v[100:103]
    s_mov_b32 s49, 1048576
    buffer_load_dwordx4 v22, s[16:19], s49 offen nt lds
    v_mfma_f32_16x16x32_bf16 v[108:111], a[124:127], a[200:203], v[108:111]
    s_add_u32 m0, s43, 57344
    ds_read_b64_tr_b16 a[218:219], v7 offset:45568
    v_mfma_f32_16x16x32_bf16 v[116:119], a[128:131], a[200:203], v[116:119]
    s_mov_b32 s49, 1048704
    buffer_load_dwordx4 v22, s[16:19], s49 offen nt lds
    v_mfma_f32_16x16x32_bf16 v[124:127], a[132:135], a[200:203], v[124:127]
    ds_read_b64_tr_b16 a[220:221], v8 offset:45056
    v_cvt_pk_bf16_f32 v81, v81, v81
    v_mfma_f32_16x16x32_bf16 v[132:135], a[136:139], a[200:203], v[132:135]
    s_waitcnt lgkmcnt(7)
    ds_read_b64_tr_b16 a[222:223], v8 offset:45568
    v_lshlrev_b32 v81, 16, v81
    v_mfma_f32_16x16x32_bf16 v[136:139], a[120:123], a[204:207], v[136:139]
    v_sqrt_f32 v82, v81
    v_mfma_f32_16x16x32_bf16 v[144:147], a[124:127], a[204:207], v[144:147]
    ds_read_b64_tr_b16 a[224:225], v9 offset:45056
    v_cvt_pk_bf16_f32 v86, v86, v86
    v_mfma_f32_16x16x32_bf16 v[152:155], a[128:131], a[204:207], v[152:155]
    ds_read_b64_tr_b16 a[226:227], v9 offset:45568
    v_lshlrev_b32 v86, 16, v86
    v_mfma_f32_16x16x32_bf16 v[160:163], a[132:135], a[204:207], v[160:163]
    s_waitcnt vmcnt(9)
    v_rcp_f32 v83, v81
    v_mfma_f32_16x16x32_bf16 v[168:171], a[136:139], a[204:207], v[168:171]
    s_waitcnt lgkmcnt(8)
    s_barrier
    v_mfma_f32_16x16x32_bf16 v[140:143], a[120:123], a[208:211], v[140:143]
    ds_read_b64_tr_b16 a[180:181], v1 offset:40960
    v_mfma_f32_16x16x32_bf16 v[148:151], a[124:127], a[208:211], v[148:151]
    ds_read_b64_tr_b16 a[182:183], v1 offset:43520
    v_mfma_f32_16x16x32_bf16 v[156:159], a[128:131], a[208:211], v[156:159]
    ds_read_b64_tr_b16 a[184:185], v2 offset:40960
    v_mfma_f32_16x16x32_bf16 v[164:167], a[132:135], a[208:211], v[164:167]
    ds_read_b64_tr_b16 a[186:187], v2 offset:43520
    v_mfma_f32_16x16x32_bf16 v[172:175], a[136:139], a[208:211], v[172:175]
    s_waitcnt lgkmcnt(10)
    ds_read_b64_tr_b16 a[188:189], v3 offset:40960
    v_mfma_f32_16x16x32_bf16 v[176:179], a[120:123], a[212:215], v[176:179]
    ds_read_b64_tr_b16 a[190:191], v3 offset:43520
    v_mfma_f32_16x16x32_bf16 v[184:187], a[124:127], a[212:215], v[184:187]
    ds_read_b64_tr_b16 a[192:193], v4 offset:40960
    v_mfma_f32_16x16x32_bf16 v[192:195], a[128:131], a[212:215], v[192:195]
    ds_read_b64_tr_b16 a[194:195], v4 offset:43520
    v_cvt_pk_bf16_f32 v82, v82, v82
    v_mfma_f32_16x16x32_bf16 v[200:203], a[132:135], a[212:215], v[200:203]
    ds_read_b64_tr_b16 a[196:197], v5 offset:40960
    v_lshlrev_b32 v82, 16, v82
    v_mfma_f32_16x16x32_bf16 v[208:211], a[136:139], a[212:215], v[208:211]
    s_waitcnt lgkmcnt(13)
    ds_read_b64_tr_b16 a[198:199], v5 offset:43520
    v_mul_f32 v83, 0x3e800000, v83
    v_mfma_f32_16x16x32_bf16 v[180:183], a[120:123], a[216:219], v[180:183]
    ds_read_b64_tr_b16 a[228:229], v6 offset:8192
    v_cvt_pk_bf16_f32 v83, v83, v83
    v_mfma_f32_16x16x32_bf16 v[188:191], a[124:127], a[216:219], v[188:191]
    ds_read_b64_tr_b16 a[230:231], v6 offset:8704
    v_lshlrev_b32 v83, 16, v83
    v_mfma_f32_16x16x32_bf16 v[196:199], a[128:131], a[216:219], v[196:199]
    ds_read_b64_tr_b16 a[232:233], v7 offset:8192
    v_mul_f32 v50, 0x3e800000, v86
    v_mfma_f32_16x16x32_bf16 v[204:207], a[132:135], a[216:219], v[204:207]
    ds_read_b64_tr_b16 a[234:235], v7 offset:8704
    v_lshrrev_b32 v91, v92, v83
    v_mfma_f32_16x16x32_bf16 v[212:215], a[136:139], a[216:219], v[212:215]
    s_waitcnt lgkmcnt(15)
    ds_read_b64_tr_b16 a[200:201], v8 offset:8192
    v_mfma_f32_16x16x32_bf16 v[216:219], a[120:123], a[220:223], v[216:219]
    buffer_load_dword v94, v31, s[24:27], 0 offen
    v_mfma_f32_16x16x32_bf16 v[224:227], a[124:127], a[220:223], v[224:227]
    ds_read_b64_tr_b16 a[202:203], v8 offset:8704
    v_lshrrev_b32 v92, 1, v30
    v_mfma_f32_16x16x32_bf16 v[232:235], a[128:131], a[220:223], v[232:235]
    s_add_u32 m0, s42, 0
    ds_read_b64_tr_b16 a[204:205], v9 offset:8192
    ds_read_b64_tr_b16 a[206:207], v9 offset:8704
    v_mfma_f32_16x16x32_bf16 v[240:243], a[132:135], a[220:223], v[240:243]
    s_waitcnt vmcnt(5) lgkmcnt(8)
    s_mov_b32 s48, 20480
    buffer_load_dwordx4 v17, s[20:23], s48 offen lds
    v_mfma_f32_16x16x32_bf16 v[248:251], a[136:139], a[220:223], v[248:251]
    s_barrier
    v_mfma_f32_16x16x32_bf16 v[220:223], a[120:123], a[224:227], v[220:223]
    ds_read_b64_tr_b16 a[160:161], v1 offset:61440
    v_mfma_f32_16x16x32_bf16 v[228:231], a[124:127], a[224:227], v[228:231]
    ds_read_b64_tr_b16 a[162:163], v1 offset:64000
    v_mfma_f32_16x16x32_bf16 v[236:239], a[128:131], a[224:227], v[236:239]
    buffer_load_dwordx4 v18, s[20:23], s48 offen offset:1024 lds
    v_mfma_f32_16x16x32_bf16 v[244:247], a[132:135], a[224:227], v[244:247]
    ds_read_b64_tr_b16 a[164:165], v2 offset:61440
    v_mfma_f32_16x16x32_bf16 v[252:255], a[136:139], a[224:227], v[252:255]
    s_waitcnt lgkmcnt(9)
    ds_read_b64_tr_b16 a[166:167], v2 offset:64000
    v_mfma_f32_16x16x32_bf16 v[96:99], a[180:183], a[228:231], v[96:99]
    ds_read_b64_tr_b16 a[168:169], v3 offset:61440
    v_mfma_f32_16x16x32_bf16 v[104:107], a[184:187], a[228:231], v[104:107]
    buffer_load_dwordx4 v19, s[20:23], s48 offen offset:2048 lds
    v_mfma_f32_16x16x32_bf16 v[112:115], a[188:191], a[228:231], v[112:115]
    ds_read_b64_tr_b16 a[170:171], v3 offset:64000
    v_lshlrev_b32 v93, 1, v29
    v_mfma_f32_16x16x32_bf16 v[120:123], a[192:195], a[228:231], v[120:123]
    ds_read_b64_tr_b16 a[172:173], v4 offset:61440
    v_xor_b32 v92, v92, v93
    v_mfma_f32_16x16x32_bf16 v[128:131], a[196:199], a[228:231], v[128:131]
    s_waitcnt lgkmcnt(11)
    ds_read_b64_tr_b16 a[174:175], v4 offset:64000
    v_mfma_f32_16x16x32_bf16 v[100:103], a[180:183], a[232:235], v[100:103]
    buffer_load_dwordx4 v20, s[20:23], s48 offen offset:3072 lds
    v_mfma_f32_16x16x32_bf16 v[108:111], a[184:187], a[232:235], v[108:111]
    ds_read_b64_tr_b16 a[176:177], v5 offset:61440
    v_min_u32 v93, 1, v92
    v_mfma_f32_16x16x32_bf16 v[116:119], a[188:191], a[232:235], v[116:119]
    ds_read_b64_tr_b16 a[178:179], v5 offset:64000
    v_add_u32 v93, -1, v93
    v_mfma_f32_16x16x32_bf16 v[124:127], a[192:195], a[232:235], v[124:127]
    s_add_u32 m0, s42, 4096
    ds_read_b64_tr_b16 a[208:209], v6 offset:49152
    v_mfma_f32_16x16x32_bf16 v[132:135], a[196:199], a[232:235], v[132:135]
    s_waitcnt lgkmcnt(13)
    buffer_load_dwordx4 v21, s[20:23], s48 offen lds
    v_mfma_f32_16x16x32_bf16 v[136:139], a[180:183], a[200:203], v[136:139]
    ds_read_b64_tr_b16 a[210:211], v6 offset:49664
    v_and_b32 v24, v93, v91
    v_mfma_f32_16x16x32_bf16 v[144:147], a[184:187], a[200:203], v[144:147]
    ds_read_b64_tr_b16 a[212:213], v7 offset:49152
    v_xor_b32 v92, 1, v92
    v_mfma_f32_16x16x32_bf16 v[152:155], a[188:191], a[200:203], v[152:155]
    s_add_u32 m0, s42, 20480
    ds_read_b64_tr_b16 a[214:215], v7 offset:49664
    v_mfma_f32_16x16x32_bf16 v[160:163], a[192:195], a[200:203], v[160:163]
    s_waitcnt vmcnt(8) lgkmcnt(4)
    s_mov_b32 s48, 122880
    buffer_load_dwordx4 v17, s[20:23], s48 offen lds
    v_mfma_f32_16x16x32_bf16 v[168:171], a[196:199], a[200:203], v[168:171]
    s_barrier
    v_mfma_f32_16x16x32_bf16 v[140:143], a[180:183], a[204:207], v[140:143]
    ds_read_b64_tr_b16 a[216:217], v8 offset:49152
    v_mfma_f32_16x16x32_bf16 v[148:151], a[184:187], a[204:207], v[148:151]
    ds_read_b64_tr_b16 a[218:219], v8 offset:49664
    v_mfma_f32_16x16x32_bf16 v[156:159], a[188:191], a[204:207], v[156:159]
    buffer_load_dwordx4 v18, s[20:23], s48 offen offset:1024 lds
    v_mfma_f32_16x16x32_bf16 v[164:167], a[192:195], a[204:207], v[164:167]
    ds_read_b64_tr_b16 a[220:221], v9 offset:49152
    v_mfma_f32_16x16x32_bf16 v[172:175], a[196:199], a[204:207], v[172:175]
    s_waitcnt lgkmcnt(5)
    ds_read_b64_tr_b16 a[222:223], v9 offset:49664
    v_mfma_f32_16x16x32_bf16 v[176:179], a[180:183], a[208:211], v[176:179]
    ds_read_b64_tr_b16 a[224:225], v6 offset:12288
    v_mfma_f32_16x16x32_bf16 v[184:187], a[184:187], a[208:211], v[184:187]
    buffer_load_dwordx4 v19, s[20:23], s48 offen offset:2048 lds
    v_mfma_f32_16x16x32_bf16 v[192:195], a[188:191], a[208:211], v[192:195]
    ds_read_b64_tr_b16 a[226:227], v6 offset:12800
    v_min_u32 v93, 1, v92
    v_mfma_f32_16x16x32_bf16 v[200:203], a[192:195], a[208:211], v[200:203]
    ds_read_b64_tr_b16 a[228:229], v7 offset:12288
    v_add_u32 v93, -1, v93
    v_mfma_f32_16x16x32_bf16 v[208:211], a[196:199], a[208:211], v[208:211]
    s_waitcnt lgkmcnt(7)
    ds_read_b64_tr_b16 a[230:231], v7 offset:12800
    v_mfma_f32_16x16x32_bf16 v[180:183], a[180:183], a[212:215], v[180:183]
    buffer_load_dwordx4 v20, s[20:23], s48 offen offset:3072 lds
    v_mfma_f32_16x16x32_bf16 v[188:191], a[184:187], a[212:215], v[188:191]
    ds_read_b64_tr_b16 a[232:233], v8 offset:12288
    v_and_b32 v25, v93, v91
    v_mfma_f32_16x16x32_bf16 v[196:199], a[188:191], a[212:215], v[196:199]
    ds_read_b64_tr_b16 a[234:235], v8 offset:12800
    v_and_b32 v59, 0xffff0000, v57
    v_mfma_f32_16x16x32_bf16 v[204:207], a[192:195], a[212:215], v[204:207]
    s_add_u32 m0, s42, 24576
    v_mfma_f32_16x16x32_bf16 v[212:215], a[196:199], a[212:215], v[212:215]
    s_waitcnt lgkmcnt(8)
    buffer_load_dwordx4 v21, s[20:23], s48 offen lds
    v_mfma_f32_16x16x32_bf16 v[216:219], a[180:183], a[216:219], v[216:219]
    v_rcp_f32 v84, v82
    v_mfma_f32_16x16x32_bf16 v[224:227], a[184:187], a[216:219], v[224:227]
    ds_read_b64_tr_b16 a[200:201], v9 offset:12288
    v_mul_f32 v85, v85, v84
    v_mfma_f32_16x16x32_bf16 v[232:235], a[188:191], a[216:219], v[232:235]
    s_add_u32 m0, s43, 20480
    ds_read_b64_tr_b16 a[202:203], v9 offset:12800
    v_mfma_f32_16x16x32_bf16 v[240:243], a[192:195], a[216:219], v[240:243]
    s_mov_b32 s49, 6291456
    buffer_load_dwordx4 v22, s[16:19], s49 offen nt lds
    v_mfma_f32_16x16x32_bf16 v[248:251], a[196:199], a[216:219], v[248:251]
    s_waitcnt lgkmcnt(8)
    s_add_u32 m0, s43, 61440
    v_mfma_f32_16x16x32_bf16 v[220:223], a[180:183], a[220:223], v[220:223]
    s_mov_b32 s49, 6291584
    buffer_load_dwordx4 v22, s[16:19], s49 offen nt lds
    v_mfma_f32_16x16x32_bf16 v[228:231], a[184:187], a[220:223], v[228:231]
    s_add_u32 m0, s43, 24576
    ds_read_b64_tr_b16 a[204:205], v6 offset:53248
    v_mfma_f32_16x16x32_bf16 v[236:239], a[188:191], a[220:223], v[236:239]
    s_mov_b32 s49, 1572864
    buffer_load_dwordx4 v22, s[16:19], s49 offen nt lds
    v_mfma_f32_16x16x32_bf16 v[244:247], a[192:195], a[220:223], v[244:247]
    s_add_u32 m0, s43, 65536
    ds_read_b64_tr_b16 a[206:207], v6 offset:53760
    v_mfma_f32_16x16x32_bf16 v[252:255], a[196:199], a[220:223], v[252:255]
    s_waitcnt lgkmcnt(8)
    s_mov_b32 s49, 1572992
    buffer_load_dwordx4 v22, s[16:19], s49 offen nt lds
    v_mfma_f32_16x16x32_bf16 v[96:99], a[160:163], a[224:227], v[96:99]
    v_cvt_pk_bf16_f32 v85, v85, v85
    v_cvt_pk_bf16_f32 v84, v84, v84
    v_mfma_f32_16x16x32_bf16 v[104:107], a[164:167], a[224:227], v[104:107]
    ds_read_b64_tr_b16 a[208:209], v7 offset:53248
    v_lshlrev_b32 v85, 16, v85
    v_mfma_f32_16x16x32_bf16 v[112:115], a[168:171], a[224:227], v[112:115]
    ds_read_b64_tr_b16 a[210:211], v7 offset:53760
    v_lshlrev_b32 v84, 16, v84
    v_mfma_f32_16x16x32_bf16 v[120:123], a[172:175], a[224:227], v[120:123]
    v_rcp_f32 v87, v85
    v_mfma_f32_16x16x32_bf16 v[128:131], a[176:179], a[224:227], v[128:131]
    s_waitcnt lgkmcnt(8)
    v_mul_f32 v26, 0xbfb8aa3b, v84
    v_mul_f32 v27, 0xbfb8aa3b, v84
    v_mfma_f32_16x16x32_bf16 v[100:103], a[160:163], a[228:231], v[100:103]
    v_mul_f32 v30, 0xbfb8aa3b, v87
    v_mul_f32 v31, 0xbfb8aa3b, v87
    v_mfma_f32_16x16x32_bf16 v[108:111], a[164:167], a[228:231], v[108:111]
    ds_read_b64_tr_b16 a[212:213], v8 offset:53248
    v_lshlrev_b32 v58, 16, v57
    v_mfma_f32_16x16x32_bf16 v[116:119], a[168:171], a[228:231], v[116:119]
    ds_read_b64_tr_b16 a[214:215], v8 offset:53760
    v_mul_f32 v58, v50, v58
    v_mfma_f32_16x16x32_bf16 v[124:127], a[172:175], a[228:231], v[124:127]
    v_mul_f32 v59, v50, v59
    v_and_b32 v57, 0xffff0000, v56
    v_mfma_f32_16x16x32_bf16 v[132:135], a[176:179], a[228:231], v[132:135]
    s_waitcnt lgkmcnt(8)
    v_cvt_pk_bf16_f32 v53, v58, v59
    v_lshlrev_b32 v56, 16, v56
    v_mfma_f32_16x16x32_bf16 v[136:139], a[160:163], a[232:235], v[136:139]
    v_lshlrev_b32 v58, 16, v53
    v_and_b32 v59, 0xffff0000, v53
    v_mfma_f32_16x16x32_bf16 v[144:147], a[164:167], a[232:235], v[144:147]
    ds_read_b64_tr_b16 a[216:217], v9 offset:53248
    v_mul_f32 v58, 0xbfb8aa3b, v58
    v_mfma_f32_16x16x32_bf16 v[152:155], a[168:171], a[232:235], v[152:155]
    ds_read_b64_tr_b16 a[218:219], v9 offset:53760
    v_mul_f32 v59, 0xbfb8aa3b, v59
    v_mfma_f32_16x16x32_bf16 v[160:163], a[172:175], a[232:235], v[160:163]
    s_waitcnt vmcnt(9)
    v_mul_f32 v56, v50, v56
    v_mul_f32 v57, v50, v57
    v_mfma_f32_16x16x32_bf16 v[168:171], a[176:179], a[232:235], v[168:171]
    s_waitcnt lgkmcnt(8)
    s_barrier
    v_mfma_f32_16x16x32_bf16 v[140:143], a[160:163], a[200:203], v[140:143]
    ds_read_b64_tr_b16 a[140:141], v1 offset:0
    v_mfma_f32_16x16x32_bf16 v[148:151], a[164:167], a[200:203], v[148:151]
    ds_read_b64_tr_b16 a[142:143], v1 offset:2560
    v_mfma_f32_16x16x32_bf16 v[156:159], a[168:171], a[200:203], v[156:159]
    ds_read_b64_tr_b16 a[144:145], v2 offset:0
    v_mfma_f32_16x16x32_bf16 v[164:167], a[172:175], a[200:203], v[164:167]
    ds_read_b64_tr_b16 a[146:147], v2 offset:2560
    v_mfma_f32_16x16x32_bf16 v[172:175], a[176:179], a[200:203], v[172:175]
    s_waitcnt lgkmcnt(10)
    ds_read_b64_tr_b16 a[148:149], v3 offset:0
    v_mfma_f32_16x16x32_bf16 v[176:179], a[160:163], a[204:207], v[176:179]
    ds_read_b64_tr_b16 a[150:151], v3 offset:2560
    v_mfma_f32_16x16x32_bf16 v[184:187], a[164:167], a[204:207], v[184:187]
    ds_read_b64_tr_b16 a[152:153], v4 offset:0
    v_mfma_f32_16x16x32_bf16 v[192:195], a[168:171], a[204:207], v[192:195]
    ds_read_b64_tr_b16 a[154:155], v4 offset:2560
    v_cvt_pk_bf16_f32 v52, v56, v57
    v_mfma_f32_16x16x32_bf16 v[200:203], a[172:175], a[204:207], v[200:203]
    ds_read_b64_tr_b16 a[156:157], v5 offset:0
    v_lshlrev_b32 v56, 16, v52
    v_mfma_f32_16x16x32_bf16 v[208:211], a[176:179], a[204:207], v[208:211]
    s_waitcnt lgkmcnt(13)
    s_add_u32 m0, s42, 40960
    ds_read_b64_tr_b16 a[158:159], v5 offset:2560
    v_mfma_f32_16x16x32_bf16 v[180:183], a[160:163], a[208:211], v[180:183]
    s_mov_b32 s48, 30720
    buffer_load_dwordx4 v17, s[20:23], s48 offen lds
    v_mfma_f32_16x16x32_bf16 v[188:191], a[164:167], a[208:211], v[188:191]
    ds_read_b64_tr_b16 a[220:221], v6 offset:16384
    v_and_b32 v57, 0xffff0000, v52
    v_mfma_f32_16x16x32_bf16 v[196:199], a[168:171], a[208:211], v[196:199]
    ds_read_b64_tr_b16 a[222:223], v6 offset:16896
    v_mul_f32 v56, 0xbfb8aa3b, v56
    v_mfma_f32_16x16x32_bf16 v[204:207], a[172:175], a[208:211], v[204:207]
    ds_read_b64_tr_b16 a[224:225], v7 offset:16384
    v_mfma_f32_16x16x32_bf16 v[212:215], a[176:179], a[208:211], v[212:215]
    s_waitcnt lgkmcnt(15)
    buffer_load_dwordx4 v18, s[20:23], s48 offen offset:1024 lds
    v_mfma_f32_16x16x32_bf16 v[216:219], a[160:163], a[212:215], v[216:219]
    ds_read_b64_tr_b16 a[226:227], v7 offset:16896
    v_mul_f32 v57, 0xbfb8aa3b, v57
    v_mfma_f32_16x16x32_bf16 v[224:227], a[164:167], a[212:215], v[224:227]
    ds_read_b64_tr_b16 a[228:229], v8 offset:16384
    ds_read_b64_tr_b16 a[232:233], v9 offset:16384
    v_mfma_f32_16x16x32_bf16 v[232:235], a[168:171], a[212:215], v[232:235]
    ds_read_b64_tr_b16 a[230:231], v8 offset:16896
    ds_read_b64_tr_b16 a[234:235], v9 offset:16896
    v_mfma_f32_16x16x32_bf16 v[240:243], a[172:175], a[212:215], v[240:243]
    s_waitcnt vmcnt(6) lgkmcnt(8)
    buffer_load_dwordx4 v19, s[20:23], s48 offen offset:2048 lds
    v_mfma_f32_16x16x32_bf16 v[248:251], a[176:179], a[212:215], v[248:251]
    s_barrier
    v_mfma_f32_16x16x32_bf16 v[220:223], a[160:163], a[216:219], v[220:223]
    ds_read_b64_tr_b16 a[120:121], v1 offset:20480
    v_mfma_f32_16x16x32_bf16 v[228:231], a[164:167], a[216:219], v[228:231]
    ds_read_b64_tr_b16 a[122:123], v1 offset:23040
    v_mfma_f32_16x16x32_bf16 v[236:239], a[168:171], a[216:219], v[236:239]
    buffer_load_dwordx4 v20, s[20:23], s48 offen offset:3072 lds
    v_mfma_f32_16x16x32_bf16 v[244:247], a[172:175], a[216:219], v[244:247]
    ds_read_b64_tr_b16 a[124:125], v2 offset:20480
    v_mfma_f32_16x16x32_bf16 v[252:255], a[176:179], a[216:219], v[252:255]
    s_waitcnt lgkmcnt(9)
    ds_read_b64_tr_b16 a[126:127], v2 offset:23040
    v_mfma_f32_16x16x32_bf16 v[96:99], a[140:143], a[220:223], v[96:99]
    s_add_u32 m0, s42, 45056
    ds_read_b64_tr_b16 a[128:129], v3 offset:20480
    v_mfma_f32_16x16x32_bf16 v[104:107], a[144:147], a[220:223], v[104:107]
    buffer_load_dwordx4 v21, s[20:23], s48 offen lds
    v_mfma_f32_16x16x32_bf16 v[112:115], a[148:151], a[220:223], v[112:115]
    ds_read_b64_tr_b16 a[130:131], v3 offset:23040
    v_and_b32 v63, 0xffff0000, v61
    v_mfma_f32_16x16x32_bf16 v[120:123], a[152:155], a[220:223], v[120:123]
    ds_read_b64_tr_b16 a[132:133], v4 offset:20480
    v_lshlrev_b32 v62, 16, v61
    v_mfma_f32_16x16x32_bf16 v[128:131], a[156:159], a[220:223], v[128:131]
    s_waitcnt lgkmcnt(11)
    s_add_u32 m0, s42, 61440
    ds_read_b64_tr_b16 a[134:135], v4 offset:23040
    v_mfma_f32_16x16x32_bf16 v[100:103], a[140:143], a[224:227], v[100:103]
    s_mov_b32 s48, 133120
    buffer_load_dwordx4 v17, s[20:23], s48 offen lds
    v_mfma_f32_16x16x32_bf16 v[108:111], a[144:147], a[224:227], v[108:111]
    ds_read_b64_tr_b16 a[136:137], v5 offset:20480
    v_mul_f32 v62, v50, v62
    v_mfma_f32_16x16x32_bf16 v[116:119], a[148:151], a[224:227], v[116:119]
    ds_read_b64_tr_b16 a[138:139], v5 offset:23040
    v_mul_f32 v63, v50, v63
    v_mfma_f32_16x16x32_bf16 v[124:127], a[152:155], a[224:227], v[124:127]
    ds_read_b64_tr_b16 a[200:201], v6 offset:57344
    v_mfma_f32_16x16x32_bf16 v[132:135], a[156:159], a[224:227], v[132:135]
    s_waitcnt lgkmcnt(12)
    buffer_load_dwordx4 v18, s[20:23], s48 offen offset:1024 lds
    v_mfma_f32_16x16x32_bf16 v[136:139], a[140:143], a[228:231], v[136:139]
    ds_read_b64_tr_b16 a[202:203], v6 offset:57856
    v_cvt_pk_bf16_f32 v55, v62, v63
    v_mfma_f32_16x16x32_bf16 v[144:147], a[144:147], a[228:231], v[144:147]
    ds_read_b64_tr_b16 a[204:205], v7 offset:57344
    v_lshlrev_b32 v62, 16, v55
    v_mfma_f32_16x16x32_bf16 v[152:155], a[148:151], a[228:231], v[152:155]
    ds_read_b64_tr_b16 a[206:207], v7 offset:57856
    v_mfma_f32_16x16x32_bf16 v[160:163], a[152:155], a[228:231], v[160:163]
    s_waitcnt vmcnt(9) lgkmcnt(4)
    buffer_load_dwordx4 v19, s[20:23], s48 offen offset:2048 lds
    v_mfma_f32_16x16x32_bf16 v[168:171], a[156:159], a[228:231], v[168:171]
    s_barrier
    v_mfma_f32_16x16x32_bf16 v[140:143], a[140:143], a[232:235], v[140:143]
    ds_read_b64_tr_b16 a[208:209], v8 offset:57344
    v_mfma_f32_16x16x32_bf16 v[148:151], a[144:147], a[232:235], v[148:151]
    ds_read_b64_tr_b16 a[210:211], v8 offset:57856
    v_mfma_f32_16x16x32_bf16 v[156:159], a[148:151], a[232:235], v[156:159]
    buffer_load_dwordx4 v20, s[20:23], s48 offen offset:3072 lds
    v_mfma_f32_16x16x32_bf16 v[164:167], a[152:155], a[232:235], v[164:167]
    ds_read_b64_tr_b16 a[212:213], v9 offset:57344
    v_mfma_f32_16x16x32_bf16 v[172:175], a[156:159], a[232:235], v[172:175]
    s_waitcnt lgkmcnt(5)
    ds_read_b64_tr_b16 a[214:215], v9 offset:57856
    v_mfma_f32_16x16x32_bf16 v[176:179], a[140:143], a[200:203], v[176:179]
    s_add_u32 m0, s42, 65536
    ds_read_b64_tr_b16 a[216:217], v6 offset:20480
    v_mfma_f32_16x16x32_bf16 v[184:187], a[144:147], a[200:203], v[184:187]
    buffer_load_dwordx4 v21, s[20:23], s48 offen lds
    v_mfma_f32_16x16x32_bf16 v[192:195], a[148:151], a[200:203], v[192:195]
    ds_read_b64_tr_b16 a[218:219], v6 offset:20992
    v_and_b32 v63, 0xffff0000, v55
    v_mfma_f32_16x16x32_bf16 v[200:203], a[152:155], a[200:203], v[200:203]
    ds_read_b64_tr_b16 a[220:221], v7 offset:20480
    v_mul_f32 v62, 0xbfb8aa3b, v62
    v_mfma_f32_16x16x32_bf16 v[208:211], a[156:159], a[200:203], v[208:211]
    s_waitcnt lgkmcnt(7)
    s_add_u32 m0, s43, 28672
    ds_read_b64_tr_b16 a[222:223], v7 offset:20992
    v_mfma_f32_16x16x32_bf16 v[180:183], a[140:143], a[204:207], v[180:183]
    s_mov_b32 s49, 6815744
    buffer_load_dwordx4 v22, s[16:19], s49 offen nt lds
    v_mfma_f32_16x16x32_bf16 v[188:191], a[144:147], a[204:207], v[188:191]
    s_add_u32 m0, s43, 69632
    ds_read_b64_tr_b16 a[224:225], v8 offset:20480
    v_mfma_f32_16x16x32_bf16 v[196:199], a[148:151], a[204:207], v[196:199]
    s_mov_b32 s49, 6815872
    buffer_load_dwordx4 v22, s[16:19], s49 offen nt lds
    v_mfma_f32_16x16x32_bf16 v[204:207], a[152:155], a[204:207], v[204:207]
    s_add_u32 m0, s43, 32768
    ds_read_b64_tr_b16 a[226:227], v8 offset:20992
    v_mfma_f32_16x16x32_bf16 v[212:215], a[156:159], a[204:207], v[212:215]
    s_waitcnt lgkmcnt(8)
    s_mov_b32 s49, 2097152
    buffer_load_dwordx4 v22, s[16:19], s49 offen nt lds
    v_mfma_f32_16x16x32_bf16 v[216:219], a[140:143], a[208:211], v[216:219]
    s_add_u32 m0, s43, 73728
    v_mfma_f32_16x16x32_bf16 v[224:227], a[144:147], a[208:211], v[224:227]
    s_mov_b32 s49, 2097280
    buffer_load_dwordx4 v22, s[16:19], s49 offen nt lds
    v_mfma_f32_16x16x32_bf16 v[232:235], a[148:151], a[208:211], v[232:235]
    ds_read_b64_tr_b16 a[228:229], v9 offset:20480
    v_mul_f32 v63, 0xbfb8aa3b, v63
    v_mfma_f32_16x16x32_bf16 v[240:243], a[152:155], a[208:211], v[240:243]
    ds_read_b64_tr_b16 a[230:231], v9 offset:20992
    v_and_b32 v61, 0xffff0000, v60
    v_mfma_f32_16x16x32_bf16 v[248:251], a[156:159], a[208:211], v[248:251]
    s_waitcnt lgkmcnt(8)
    v_lshlrev_b32 v60, 16, v60
    v_mul_f32 v61, v50, v61
    v_mfma_f32_16x16x32_bf16 v[220:223], a[140:143], a[212:215], v[220:223]
    v_mul_f32 v60, v50, v60
    v_and_b32 v67, 0xffff0000, v65
    v_mfma_f32_16x16x32_bf16 v[228:231], a[144:147], a[212:215], v[228:231]
    ds_read_b64_tr_b16 a[232:233], v6 offset:61440
    v_cvt_pk_bf16_f32 v54, v60, v61
    v_mfma_f32_16x16x32_bf16 v[236:239], a[148:151], a[212:215], v[236:239]
    ds_read_b64_tr_b16 a[234:235], v6 offset:61952
    v_lshlrev_b32 v60, 16, v54
    v_mfma_f32_16x16x32_bf16 v[244:247], a[152:155], a[212:215], v[244:247]
    v_and_b32 v61, 0xffff0000, v54
    v_mul_f32 v60, 0xbfb8aa3b, v60
    v_mfma_f32_16x16x32_bf16 v[252:255], a[156:159], a[212:215], v[252:255]
    s_waitcnt lgkmcnt(8)
    v_mul_f32 v61, 0xbfb8aa3b, v61
    v_lshlrev_b32 v66, 16, v65
    v_mfma_f32_16x16x32_bf16 v[96:99], a[120:123], a[216:219], v[96:99]
    ds_read_b64_tr_b16 a[236:237], v10 offset:0
    v_mul_f32 v66, v50, v66
    v_mfma_f32_16x16x32_bf16 v[104:107], a[124:127], a[216:219], v[104:107]
    ds_read_b64_tr_b16 a[200:201], v7 offset:61440
    v_mul_f32 v67, v50, v67
    v_mfma_f32_16x16x32_bf16 v[112:115], a[128:131], a[216:219], v[112:115]
    ds_read_b64_tr_b16 a[202:203], v7 offset:61952
    v_cvt_pk_bf16_f32 v53, v66, v67
    v_mfma_f32_16x16x32_bf16 v[120:123], a[132:135], a[216:219], v[120:123]
    ds_read_b64_tr_b16 a[238:239], v11 offset:0
    v_lshlrev_b32 v66, 16, v53
    v_mfma_f32_16x16x32_bf16 v[128:131], a[136:139], a[216:219], v[128:131]
    s_waitcnt lgkmcnt(10)
    ds_read_b64_tr_b16 v[76:77], v12 offset:0
    v_and_b32 v67, 0xffff0000, v53
    v_mfma_f32_16x16x32_bf16 v[100:103], a[120:123], a[220:223], v[100:103]
    ds_read_b64_tr_b16 v[78:79], v13 offset:0
    v_mul_f32 v66, 0xbfb8aa3b, v66
    v_mfma_f32_16x16x32_bf16 v[108:111], a[124:127], a[220:223], v[108:111]
    ds_read_b64_tr_b16 a[204:205], v8 offset:61440
    v_mul_f32 v67, 0xbfb8aa3b, v67
    v_mfma_f32_16x16x32_bf16 v[116:119], a[128:131], a[220:223], v[116:119]
    ds_read_b64_tr_b16 a[206:207], v8 offset:61952
    v_and_b32 v65, 0xffff0000, v64
    v_mfma_f32_16x16x32_bf16 v[124:127], a[132:135], a[220:223], v[124:127]
    v_lshlrev_b32 v64, 16, v64
    v_mul_f32 v65, v50, v65
    v_mfma_f32_16x16x32_bf16 v[132:135], a[136:139], a[220:223], v[132:135]
    s_waitcnt lgkmcnt(12)
    v_mul_f32 v64, v50, v64
    v_and_b32 v71, 0xffff0000, v69
    v_mfma_f32_16x16x32_bf16 v[136:139], a[120:123], a[224:227], v[136:139]
    v_cvt_pk_bf16_f32 v52, v64, v65
    v_lshlrev_b32 v70, 16, v69
    v_mfma_f32_16x16x32_bf16 v[144:147], a[124:127], a[224:227], v[144:147]
    ds_read_b64_tr_b16 a[208:209], v9 offset:61440
    v_lshlrev_b32 v64, 16, v52
    v_mfma_f32_16x16x32_bf16 v[152:155], a[128:131], a[224:227], v[152:155]
    ds_read_b64_tr_b16 a[210:211], v9 offset:61952
    v_and_b32 v65, 0xffff0000, v52
    v_mfma_f32_16x16x32_bf16 v[160:163], a[132:135], a[224:227], v[160:163]
    s_waitcnt vmcnt(9)
    v_mul_f32 v64, 0xbfb8aa3b, v64
    v_mul_f32 v65, 0xbfb8aa3b, v65
    v_mfma_f32_16x16x32_bf16 v[168:171], a[136:139], a[224:227], v[168:171]
    s_waitcnt lgkmcnt(12)
    s_barrier
    v_mfma_f32_16x16x32_bf16 v[140:143], a[120:123], a[228:231], v[140:143]
    ds_read_b64_tr_b16 a[180:181], v1 offset:40960
    ds_read_b64_tr_b16 a[240:241], v10 offset:8192
    v_mfma_f32_16x16x32_bf16 v[148:151], a[124:127], a[228:231], v[148:151]
    s_add_u32 m0, s42, 0
    ds_read_b64_tr_b16 a[182:183], v1 offset:43520
    ds_read_b64_tr_b16 a[242:243], v11 offset:8192
    v_mfma_f32_16x16x32_bf16 v[156:159], a[128:131], a[228:231], v[156:159]
    s_mov_b32 s48, 40960
    ds_read_b64_tr_b16 v[80:81], v12 offset:8192
    buffer_load_dwordx4 v17, s[20:23], s48 offen lds
    v_mfma_f32_16x16x32_bf16 v[164:167], a[132:135], a[228:231], v[164:167]
    ds_read_b64_tr_b16 a[184:185], v2 offset:40960
    ds_read_b64_tr_b16 v[82:83], v13 offset:8192
    v_mfma_f32_16x16x32_bf16 v[172:175], a[136:139], a[228:231], v[172:175]
    s_waitcnt lgkmcnt(15)
    ds_read_b64_tr_b16 a[186:187], v2 offset:43520
    v_mfma_f32_16x16x32_bf16 v[176:179], a[120:123], a[232:235], v[176:179]
    ds_read_b64_tr_b16 a[188:189], v3 offset:40960
    v_mfma_f32_16x16x32_bf16 v[184:187], a[124:127], a[232:235], v[184:187]
    buffer_load_dwordx4 v18, s[20:23], s48 offen offset:1024 lds
    v_mfma_f32_16x16x32_bf16 v[192:195], a[128:131], a[232:235], v[192:195]
    ds_read_b64_tr_b16 a[190:191], v3 offset:43520
    v_mul_f32 v70, v50, v70
    v_mfma_f32_16x16x32_bf16 v[200:203], a[132:135], a[232:235], v[200:203]
    ds_read_b64_tr_b16 a[192:193], v4 offset:40960
    v_mul_f32 v71, v50, v71
    v_mfma_f32_16x16x32_bf16 v[208:211], a[136:139], a[232:235], v[208:211]
    s_waitcnt lgkmcnt(15)
    ds_read_b64_tr_b16 a[194:195], v4 offset:43520
    v_mfma_f32_16x16x32_bf16 v[180:183], a[120:123], a[200:203], v[180:183]
    buffer_load_dwordx4 v19, s[20:23], s48 offen offset:2048 lds
    v_mfma_f32_16x16x32_bf16 v[188:191], a[124:127], a[200:203], v[188:191]
    ds_read_b64_tr_b16 a[196:197], v5 offset:40960
    v_add_u32 v8, 24576, v8
    ds_read_b64_tr_b16 a[220:221], v8 offset:0
    v_mfma_f32_16x16x32_bf16 v[196:199], a[128:131], a[200:203], v[196:199]
    ds_read_b64_tr_b16 a[198:199], v5 offset:43520
    ds_read_b64_tr_b16 a[222:223], v8 offset:512
    v_mfma_f32_16x16x32_bf16 v[204:207], a[132:135], a[200:203], v[204:207]
    v_add_u32 v6, 24576, v6
    ds_read_b64_tr_b16 a[212:213], v6 offset:0
    v_mfma_f32_16x16x32_bf16 v[212:215], a[136:139], a[200:203], v[212:215]
    s_waitcnt lgkmcnt(15)
    buffer_load_dwordx4 v20, s[20:23], s48 offen offset:3072 lds
    v_mfma_f32_16x16x32_bf16 v[216:219], a[120:123], a[204:207], v[216:219]
    ds_read_b64_tr_b16 a[214:215], v6 offset:512
    ds_read_b64_tr_b16 a[244:245], v10 offset:16384
    v_mfma_f32_16x16x32_bf16 v[224:227], a[124:127], a[204:207], v[224:227]
    v_add_u32 v7, 24576, v7
    ds_read_b64_tr_b16 a[216:217], v7 offset:0
    v_mfma_f32_16x16x32_bf16 v[232:235], a[128:131], a[204:207], v[232:235]
    s_add_u32 m0, s42, 4096
    ds_read_b64_tr_b16 a[218:219], v7 offset:512
    v_add_u32 v9, 24576, v9
    ds_read_b64_tr_b16 a[224:225], v9 offset:0
    v_mfma_f32_16x16x32_bf16 v[240:243], a[132:135], a[204:207], v[240:243]
    s_waitcnt vmcnt(8) lgkmcnt(7)
    ds_read_b64_tr_b16 a[226:227], v9 offset:512
    buffer_load_dwordx4 v21, s[20:23], s48 offen lds
    v_mfma_f32_16x16x32_bf16 v[248:251], a[136:139], a[204:207], v[248:251]
    s_barrier
    v_mfma_f32_16x16x32_bf16 v[220:223], a[120:123], a[208:211], v[220:223]
    ds_read_b64_tr_b16 a[160:161], v1 offset:61440
    ds_read_b64_tr_b16 a[246:247], v11 offset:16384
    v_mfma_f32_16x16x32_bf16 v[228:231], a[124:127], a[208:211], v[228:231]
    s_add_u32 m0, s42, 20480
    ds_read_b64_tr_b16 a[162:163], v1 offset:64000
    ds_read_b64_tr_b16 v[84:85], v12 offset:16384
    v_mfma_f32_16x16x32_bf16 v[236:239], a[128:131], a[208:211], v[236:239]
    s_mov_b32 s48, 143360
    ds_read_b64_tr_b16 v[86:87], v13 offset:16384
    buffer_load_dwordx4 v17, s[20:23], s48 offen lds
    v_mfma_f32_16x16x32_bf16 v[244:247], a[132:135], a[208:211], v[244:247]
    ds_read_b64_tr_b16 a[164:165], v2 offset:61440
    v_mfma_f32_16x16x32_bf16 v[252:255], a[136:139], a[208:211], v[252:255]
    s_waitcnt lgkmcnt(11)
    ds_read_b64_tr_b16 a[166:167], v2 offset:64000
    v_mfma_f32_16x16x32_bf16 v[96:99], a[180:183], a[212:215], v[96:99]
    ds_read_b64_tr_b16 a[168:169], v3 offset:61440
    v_mfma_f32_16x16x32_bf16 v[104:107], a[184:187], a[212:215], v[104:107]
    buffer_load_dwordx4 v18, s[20:23], s48 offen offset:1024 lds
    v_mfma_f32_16x16x32_bf16 v[112:115], a[188:191], a[212:215], v[112:115]
    ds_read_b64_tr_b16 a[170:171], v3 offset:64000
    v_cvt_pk_bf16_f32 v55, v70, v71
    v_mfma_f32_16x16x32_bf16 v[120:123], a[192:195], a[212:215], v[120:123]
    ds_read_b64_tr_b16 a[172:173], v4 offset:61440
    v_lshlrev_b32 v70, 16, v55
    v_mfma_f32_16x16x32_bf16 v[128:131], a[196:199], a[212:215], v[128:131]
    s_waitcnt lgkmcnt(12)
    ds_read_b64_tr_b16 a[174:175], v4 offset:64000
    v_mfma_f32_16x16x32_bf16 v[100:103], a[180:183], a[216:219], v[100:103]
    buffer_load_dwordx4 v19, s[20:23], s48 offen offset:2048 lds
    v_mfma_f32_16x16x32_bf16 v[108:111], a[184:187], a[216:219], v[108:111]
    ds_read_b64_tr_b16 a[176:177], v5 offset:61440
    v_and_b32 v71, 0xffff0000, v55
    v_mfma_f32_16x16x32_bf16 v[116:119], a[188:191], a[216:219], v[116:119]
    ds_read_b64_tr_b16 a[178:179], v5 offset:64000
    v_mul_f32 v70, 0xbfb8aa3b, v70
    v_mfma_f32_16x16x32_bf16 v[124:127], a[192:195], a[216:219], v[124:127]
    ds_read_b64_tr_b16 a[228:229], v6 offset:40960
    v_mfma_f32_16x16x32_bf16 v[132:135], a[196:199], a[216:219], v[132:135]
    buffer_load_dwordx4 v20, s[20:23], s48 offen offset:3072 lds
    v_mfma_f32_16x16x32_bf16 v[136:139], a[180:183], a[220:223], v[136:139]
    ds_read_b64_tr_b16 a[230:231], v6 offset:41472
    v_mul_f32 v71, 0xbfb8aa3b, v71
    v_mfma_f32_16x16x32_bf16 v[144:147], a[184:187], a[220:223], v[144:147]
    ds_read_b64_tr_b16 a[232:233], v7 offset:40960
    v_and_b32 v69, 0xffff0000, v68
    v_mfma_f32_16x16x32_bf16 v[152:155], a[188:191], a[220:223], v[152:155]
    s_add_u32 m0, s42, 24576
    ds_read_b64_tr_b16 a[234:235], v7 offset:41472
    v_mfma_f32_16x16x32_bf16 v[160:163], a[192:195], a[220:223], v[160:163]
    s_waitcnt vmcnt(11) lgkmcnt(4)
    buffer_load_dwordx4 v21, s[20:23], s48 offen lds
    v_mfma_f32_16x16x32_bf16 v[168:171], a[196:199], a[220:223], v[168:171]
    s_barrier
    v_mfma_f32_16x16x32_bf16 v[140:143], a[180:183], a[224:227], v[140:143]
    ds_read_b64_tr_b16 a[200:201], v8 offset:40960
    v_mfma_f32_16x16x32_bf16 v[148:151], a[184:187], a[224:227], v[148:151]
    s_add_u32 m0, s43, 36864
    ds_read_b64_tr_b16 a[202:203], v8 offset:41472
    v_mfma_f32_16x16x32_bf16 v[156:159], a[188:191], a[224:227], v[156:159]
    s_mov_b32 s49, 7340032
    buffer_load_dwordx4 v22, s[16:19], s49 offen nt lds
    v_mfma_f32_16x16x32_bf16 v[164:167], a[192:195], a[224:227], v[164:167]
    s_add_u32 m0, s43, 77824
    ds_read_b64_tr_b16 a[204:205], v9 offset:40960
    v_mfma_f32_16x16x32_bf16 v[172:175], a[196:199], a[224:227], v[172:175]
    s_waitcnt lgkmcnt(5)
    s_mov_b32 s49, 7340160
    buffer_load_dwordx4 v22, s[16:19], s49 offen nt lds
    v_mfma_f32_16x16x32_bf16 v[176:179], a[180:183], a[228:231], v[176:179]
    ds_read_b64_tr_b16 a[206:207], v9 offset:41472
    v_mfma_f32_16x16x32_bf16 v[184:187], a[184:187], a[228:231], v[184:187]
    ds_read_b64_tr_b16 a[208:209], v6 offset:4096
    v_mfma_f32_16x16x32_bf16 v[192:195], a[188:191], a[228:231], v[192:195]
    ds_read_b64_tr_b16 a[210:211], v6 offset:4608
    v_lshlrev_b32 v68, 16, v68
    v_mfma_f32_16x16x32_bf16 v[200:203], a[192:195], a[228:231], v[200:203]
    ds_read_b64_tr_b16 a[212:213], v7 offset:4096
    v_mul_f32 v68, v50, v68
    v_mfma_f32_16x16x32_bf16 v[208:211], a[196:199], a[228:231], v[208:211]
    s_waitcnt lgkmcnt(7)
    ds_read_b64_tr_b16 a[214:215], v7 offset:4608
    v_mul_f32 v69, v50, v69
    v_mfma_f32_16x16x32_bf16 v[180:183], a[180:183], a[232:235], v[180:183]
    ds_read_b64_tr_b16 a[248:249], v10 offset:24576
    v_cvt_pk_bf16_f32 v54, v68, v69
    v_mfma_f32_16x16x32_bf16 v[188:191], a[184:187], a[232:235], v[188:191]
    ds_read_b64_tr_b16 a[216:217], v8 offset:4096
    v_lshlrev_b32 v68, 16, v54
    v_mfma_f32_16x16x32_bf16 v[196:199], a[188:191], a[232:235], v[196:199]
    ds_read_b64_tr_b16 a[218:219], v8 offset:4608
    v_and_b32 v69, 0xffff0000, v54
    v_mfma_f32_16x16x32_bf16 v[204:207], a[192:195], a[232:235], v[204:207]
    ds_read_b64_tr_b16 a[250:251], v11 offset:24576
    v_mul_f32 v68, 0xbfb8aa3b, v68
    v_mfma_f32_16x16x32_bf16 v[212:215], a[196:199], a[232:235], v[212:215]
    s_waitcnt lgkmcnt(10)
    ds_read_b64_tr_b16 v[88:89], v12 offset:24576
    v_mul_f32 v69, 0xbfb8aa3b, v69
    v_mfma_f32_16x16x32_bf16 v[216:219], a[180:183], a[200:203], v[216:219]
    ds_read_b64_tr_b16 v[90:91], v13 offset:24576
    v_and_b32 v75, 0xffff0000, v73
    v_mfma_f32_16x16x32_bf16 v[224:227], a[184:187], a[200:203], v[224:227]
    ds_read_b64_tr_b16 a[220:221], v9 offset:4096
    v_lshlrev_b32 v74, 16, v73
    v_mfma_f32_16x16x32_bf16 v[232:235], a[188:191], a[200:203], v[232:235]
    ds_read_b64_tr_b16 a[222:223], v9 offset:4608
    v_mul_f32 v74, v50, v74
    v_mfma_f32_16x16x32_bf16 v[240:243], a[192:195], a[200:203], v[240:243]
    s_waitcnt vmcnt(7)
    v_mul_f32 v75, v50, v75
    v_and_b32 v73, 0xffff0000, v72
    v_mfma_f32_16x16x32_bf16 v[248:251], a[196:199], a[200:203], v[248:251]
    s_waitcnt lgkmcnt(12)
    s_barrier
    v_mfma_f32_16x16x32_bf16 v[220:223], a[180:183], a[204:207], v[220:223]
    ds_read_b64_tr_b16 a[140:141], v1 offset:0
    v_mfma_f32_16x16x32_bf16 v[228:231], a[184:187], a[204:207], v[228:231]
    ds_read_b64_tr_b16 a[142:143], v1 offset:2560
    v_mfma_f32_16x16x32_bf16 v[236:239], a[188:191], a[204:207], v[236:239]
    ds_read_b64_tr_b16 a[144:145], v2 offset:0
    v_mfma_f32_16x16x32_bf16 v[244:247], a[192:195], a[204:207], v[244:247]
    ds_read_b64_tr_b16 a[146:147], v2 offset:2560
    v_mfma_f32_16x16x32_bf16 v[252:255], a[196:199], a[204:207], v[252:255]
    s_waitcnt lgkmcnt(14)
    ds_read_b64_tr_b16 a[148:149], v3 offset:0
    v_mfma_f32_16x16x32_bf16 v[96:99], a[160:163], a[208:211], v[96:99]
    ds_read_b64_tr_b16 a[150:151], v3 offset:2560
    v_mfma_f32_16x16x32_bf16 v[104:107], a[164:167], a[208:211], v[104:107]
    ds_read_b64_tr_b16 a[152:153], v4 offset:0
    v_mfma_f32_16x16x32_bf16 v[112:115], a[168:171], a[208:211], v[112:115]
    ds_read_b64_tr_b16 a[154:155], v4 offset:2560
    v_cvt_pk_bf16_f32 v53, v74, v75
    v_mfma_f32_16x16x32_bf16 v[120:123], a[172:175], a[208:211], v[120:123]
    ds_read_b64_tr_b16 a[156:157], v5 offset:0
    v_lshlrev_b32 v74, 16, v53
    v_mfma_f32_16x16x32_bf16 v[128:131], a[176:179], a[208:211], v[128:131]
    s_waitcnt lgkmcnt(15)
    s_add_u32 m0, s42, 40960
    ds_read_b64_tr_b16 a[158:159], v5 offset:2560
    v_mfma_f32_16x16x32_bf16 v[100:103], a[160:163], a[212:215], v[100:103]
    s_mov_b32 s48, 0
    buffer_load_dwordx4 v17, s[24:27], s48 offen lds
    v_mfma_f32_16x16x32_bf16 v[108:111], a[164:167], a[212:215], v[108:111]
    ds_read_b64_tr_b16 a[224:225], v6 offset:45056
    v_and_b32 v75, 0xffff0000, v53
    v_mfma_f32_16x16x32_bf16 v[116:119], a[168:171], a[212:215], v[116:119]
    ds_read_b64_tr_b16 a[226:227], v6 offset:45568
    v_mul_f32 v74, 0xbfb8aa3b, v74
    v_mfma_f32_16x16x32_bf16 v[124:127], a[172:175], a[212:215], v[124:127]
    ds_read_b64_tr_b16 a[228:229], v7 offset:45056
    v_mfma_f32_16x16x32_bf16 v[132:135], a[176:179], a[212:215], v[132:135]
    s_waitcnt lgkmcnt(15)
    buffer_load_dwordx4 v18, s[24:27], s48 offen offset:1024 lds
    v_mfma_f32_16x16x32_bf16 v[136:139], a[160:163], a[216:219], v[136:139]
    ds_read_b64_tr_b16 a[230:231], v7 offset:45568
    v_mul_f32 v75, 0xbfb8aa3b, v75
    v_mfma_f32_16x16x32_bf16 v[144:147], a[164:167], a[216:219], v[144:147]
    ds_read_b64_tr_b16 a[232:233], v8 offset:45056
    ds_read_b64_tr_b16 a[200:201], v9 offset:45056
    v_mfma_f32_16x16x32_bf16 v[152:155], a[168:171], a[216:219], v[152:155]
    ds_read_b64_tr_b16 a[234:235], v8 offset:45568
    ds_read_b64_tr_b16 a[202:203], v9 offset:45568
    v_mfma_f32_16x16x32_bf16 v[160:163], a[172:175], a[216:219], v[160:163]
    s_waitcnt vmcnt(4) lgkmcnt(8)
    buffer_load_dwordx4 v19, s[24:27], s48 offen offset:2048 lds
    v_mfma_f32_16x16x32_bf16 v[168:171], a[176:179], a[216:219], v[168:171]
    s_barrier
    v_mfma_f32_16x16x32_bf16 v[140:143], a[160:163], a[220:223], v[140:143]
    ds_read_b64_tr_b16 a[120:121], v1 offset:20480
    v_mfma_f32_16x16x32_bf16 v[148:151], a[164:167], a[220:223], v[148:151]
    ds_read_b64_tr_b16 a[122:123], v1 offset:23040
    v_mfma_f32_16x16x32_bf16 v[156:159], a[168:171], a[220:223], v[156:159]
    buffer_load_dwordx4 v20, s[24:27], s48 offen offset:3072 lds
    v_mfma_f32_16x16x32_bf16 v[164:167], a[172:175], a[220:223], v[164:167]
    ds_read_b64_tr_b16 a[124:125], v2 offset:20480
    v_mfma_f32_16x16x32_bf16 v[172:175], a[176:179], a[220:223], v[172:175]
    s_waitcnt lgkmcnt(9)
    ds_read_b64_tr_b16 a[126:127], v2 offset:23040
    v_mfma_f32_16x16x32_bf16 v[176:179], a[160:163], a[224:227], v[176:179]
    s_add_u32 m0, s42, 45056
    ds_read_b64_tr_b16 a[128:129], v3 offset:20480
    v_mfma_f32_16x16x32_bf16 v[184:187], a[164:167], a[224:227], v[184:187]
    buffer_load_dwordx4 v21, s[24:27], s48 offen lds
    v_mfma_f32_16x16x32_bf16 v[192:195], a[168:171], a[224:227], v[192:195]
    ds_read_b64_tr_b16 a[130:131], v3 offset:23040
    v_lshlrev_b32 v72, 16, v72
    v_mfma_f32_16x16x32_bf16 v[200:203], a[172:175], a[224:227], v[200:203]
    ds_read_b64_tr_b16 a[132:133], v4 offset:20480
    v_mul_f32 v72, v50, v72
    v_mfma_f32_16x16x32_bf16 v[208:211], a[176:179], a[224:227], v[208:211]
    s_waitcnt lgkmcnt(11)
    s_add_u32 m0, s42, 61440
    ds_read_b64_tr_b16 a[134:135], v4 offset:23040
    v_mfma_f32_16x16x32_bf16 v[180:183], a[160:163], a[228:231], v[180:183]
    s_mov_b32 s48, 102400
    buffer_load_dwordx4 v17, s[24:27], s48 offen lds
    v_mfma_f32_16x16x32_bf16 v[188:191], a[164:167], a[228:231], v[188:191]
    ds_read_b64_tr_b16 a[136:137], v5 offset:20480
    v_mul_f32 v73, v50, v73
    v_mfma_f32_16x16x32_bf16 v[196:199], a[168:171], a[228:231], v[196:199]
    ds_read_b64_tr_b16 a[138:139], v5 offset:23040
    v_cvt_pk_bf16_f32 v52, v72, v73
    v_mfma_f32_16x16x32_bf16 v[204:207], a[172:175], a[228:231], v[204:207]
    ds_read_b64_tr_b16 a[204:205], v6 offset:8192
    v_mfma_f32_16x16x32_bf16 v[212:215], a[176:179], a[228:231], v[212:215]
    s_waitcnt lgkmcnt(12)
    buffer_load_dwordx4 v18, s[24:27], s48 offen offset:1024 lds
    v_mfma_f32_16x16x32_bf16 v[216:219], a[160:163], a[232:235], v[216:219]
    ds_read_b64_tr_b16 a[206:207], v6 offset:8704
    v_lshlrev_b32 v72, 16, v52
    v_mfma_f32_16x16x32_bf16 v[224:227], a[164:167], a[232:235], v[224:227]
    ds_read_b64_tr_b16 a[208:209], v7 offset:8192
    v_and_b32 v73, 0xffff0000, v52
    v_mfma_f32_16x16x32_bf16 v[232:235], a[168:171], a[232:235], v[232:235]
    ds_read_b64_tr_b16 a[210:211], v7 offset:8704
    v_mfma_f32_16x16x32_bf16 v[240:243], a[172:175], a[232:235], v[240:243]
    s_waitcnt lgkmcnt(4)
    buffer_load_dwordx4 v19, s[24:27], s48 offen offset:2048 lds
    v_mfma_f32_16x16x32_bf16 v[248:251], a[176:179], a[232:235], v[248:251]
    s_barrier
    v_mfma_f32_16x16x32_bf16 v[220:223], a[160:163], a[200:203], v[220:223]
    ds_read_b64_tr_b16 a[212:213], v8 offset:8192
    v_mfma_f32_16x16x32_bf16 v[228:231], a[164:167], a[200:203], v[228:231]
    ds_read_b64_tr_b16 a[214:215], v8 offset:8704
    v_mfma_f32_16x16x32_bf16 v[236:239], a[168:171], a[200:203], v[236:239]
    buffer_load_dwordx4 v20, s[24:27], s48 offen offset:3072 lds
    v_mfma_f32_16x16x32_bf16 v[244:247], a[172:175], a[200:203], v[244:247]
    ds_read_b64_tr_b16 a[216:217], v9 offset:8192
    v_mfma_f32_16x16x32_bf16 v[252:255], a[176:179], a[200:203], v[252:255]
    s_waitcnt lgkmcnt(5)
    ds_read_b64_tr_b16 a[218:219], v9 offset:8704
    v_mfma_f32_16x16x32_bf16 v[96:99], a[140:143], a[204:207], v[96:99]
    s_add_u32 m0, s42, 65536
    ds_read_b64_tr_b16 a[220:221], v6 offset:49152
    v_mfma_f32_16x16x32_bf16 v[104:107], a[144:147], a[204:207], v[104:107]
    buffer_load_dwordx4 v21, s[24:27], s48 offen lds
    v_mfma_f32_16x16x32_bf16 v[112:115], a[148:151], a[204:207], v[112:115]
    ds_read_b64_tr_b16 a[222:223], v6 offset:49664
    v_mul_f32 v72, 0xbfb8aa3b, v72
    v_mfma_f32_16x16x32_bf16 v[120:123], a[152:155], a[204:207], v[120:123]
    ds_read_b64_tr_b16 a[224:225], v7 offset:49152
    v_mul_f32 v73, 0xbfb8aa3b, v73
    v_mfma_f32_16x16x32_bf16 v[128:131], a[156:159], a[204:207], v[128:131]
    s_waitcnt lgkmcnt(7)
    s_add_u32 m0, s42, 0
    ds_read_b64_tr_b16 a[226:227], v7 offset:49664
    v_mfma_f32_16x16x32_bf16 v[100:103], a[140:143], a[208:211], v[100:103]
    s_mov_b32 s48, 10240
    buffer_load_dwordx4 v17, s[24:27], s48 offen lds
    v_mfma_f32_16x16x32_bf16 v[108:111], a[144:147], a[208:211], v[108:111]
    ds_read_b64_tr_b16 a[228:229], v8 offset:49152
    v_mfma_f32_16x16x32_bf16 v[116:119], a[148:151], a[208:211], v[116:119]
    ds_read_b64_tr_b16 a[230:231], v8 offset:49664
    v_mfma_f32_16x16x32_bf16 v[124:127], a[152:155], a[208:211], v[124:127]
    v_mfma_f32_16x16x32_bf16 v[132:135], a[156:159], a[208:211], v[132:135]
    s_waitcnt lgkmcnt(8)
    buffer_load_dwordx4 v18, s[24:27], s48 offen offset:1024 lds
    v_mfma_f32_16x16x32_bf16 v[136:139], a[140:143], a[212:215], v[136:139]
    v_mfma_f32_16x16x32_bf16 v[144:147], a[144:147], a[212:215], v[144:147]
    ds_read_b64_tr_b16 a[232:233], v9 offset:49152
    v_mfma_f32_16x16x32_bf16 v[152:155], a[148:151], a[212:215], v[152:155]
    ds_read_b64_tr_b16 a[234:235], v9 offset:49664
    v_mfma_f32_16x16x32_bf16 v[160:163], a[152:155], a[212:215], v[160:163]
    s_waitcnt vmcnt(7)
    buffer_load_dwordx4 v19, s[24:27], s48 offen offset:2048 lds
    v_mfma_f32_16x16x32_bf16 v[168:171], a[156:159], a[212:215], v[168:171]
    s_waitcnt lgkmcnt(8)
    s_barrier
    v_mfma_f32_16x16x32_bf16 v[140:143], a[140:143], a[216:219], v[140:143]
    ds_read_b64_tr_b16 a[0:1], v1 offset:40960
    v_mfma_f32_16x16x32_bf16 v[148:151], a[144:147], a[216:219], v[148:151]
    ds_read_b64_tr_b16 a[2:3], v1 offset:43520
    v_mfma_f32_16x16x32_bf16 v[156:159], a[148:151], a[216:219], v[156:159]
    buffer_load_dwordx4 v20, s[24:27], s48 offen offset:3072 lds
    v_mfma_f32_16x16x32_bf16 v[164:167], a[152:155], a[216:219], v[164:167]
    ds_read_b64_tr_b16 a[4:5], v2 offset:40960
    ds_read_b64_tr_b16 a[252:253], v10 offset:32768
    v_mfma_f32_16x16x32_bf16 v[172:175], a[156:159], a[216:219], v[172:175]
    s_waitcnt lgkmcnt(10)
    ds_read_b64_tr_b16 a[6:7], v2 offset:43520
    ds_read_b64_tr_b16 a[254:255], v11 offset:32768
    v_mfma_f32_16x16x32_bf16 v[176:179], a[140:143], a[220:223], v[176:179]
    s_add_u32 m0, s42, 4096
    ds_read_b64_tr_b16 a[8:9], v3 offset:40960
    ds_read_b64_tr_b16 v[92:93], v12 offset:32768
    v_mfma_f32_16x16x32_bf16 v[184:187], a[144:147], a[220:223], v[184:187]
    ds_read_b64_tr_b16 v[94:95], v13 offset:32768
    buffer_load_dwordx4 v21, s[24:27], s48 offen lds
    v_mfma_f32_16x16x32_bf16 v[192:195], a[148:151], a[220:223], v[192:195]
    ds_read_b64_tr_b16 a[10:11], v3 offset:43520
    v_mfma_f32_16x16x32_bf16 v[200:203], a[152:155], a[220:223], v[200:203]
    ds_read_b64_tr_b16 a[12:13], v4 offset:40960
    v_mfma_f32_16x16x32_bf16 v[208:211], a[156:159], a[220:223], v[208:211]
    s_waitcnt lgkmcnt(15)
    s_add_u32 m0, s42, 20480
    ds_read_b64_tr_b16 a[14:15], v4 offset:43520
    v_mfma_f32_16x16x32_bf16 v[180:183], a[140:143], a[224:227], v[180:183]
    s_mov_b32 s48, 112640
    buffer_load_dwordx4 v17, s[24:27], s48 offen lds
    v_mfma_f32_16x16x32_bf16 v[188:191], a[144:147], a[224:227], v[188:191]
    ds_read_b64_tr_b16 a[16:17], v5 offset:40960
    ds_read_b64_tr_b16 a[208:209], v8 offset:12288
    v_mfma_f32_16x16x32_bf16 v[196:199], a[148:151], a[224:227], v[196:199]
    ds_read_b64_tr_b16 a[18:19], v5 offset:43520
    ds_read_b64_tr_b16 a[210:211], v8 offset:12800
    v_mfma_f32_16x16x32_bf16 v[204:207], a[152:155], a[224:227], v[204:207]
    ds_read_b64_tr_b16 a[200:201], v6 offset:12288
    v_mfma_f32_16x16x32_bf16 v[212:215], a[156:159], a[224:227], v[212:215]
    s_waitcnt lgkmcnt(15)
    buffer_load_dwordx4 v18, s[24:27], s48 offen offset:1024 lds
    v_mfma_f32_16x16x32_bf16 v[216:219], a[140:143], a[228:231], v[216:219]
    ds_read_b64_tr_b16 a[202:203], v6 offset:12800
    v_mfma_f32_16x16x32_bf16 v[224:227], a[144:147], a[228:231], v[224:227]
    ds_read_b64_tr_b16 a[204:205], v7 offset:12288
    ds_read_b64_tr_b16 a[212:213], v9 offset:12288
    v_mfma_f32_16x16x32_bf16 v[232:235], a[148:151], a[228:231], v[232:235]
    ds_read_b64_tr_b16 a[206:207], v7 offset:12800
    ds_read_b64_tr_b16 a[214:215], v9 offset:12800
    v_mfma_f32_16x16x32_bf16 v[240:243], a[152:155], a[228:231], v[240:243]
    s_waitcnt vmcnt(7) lgkmcnt(7)
    buffer_load_dwordx4 v19, s[24:27], s48 offen offset:2048 lds
    v_mfma_f32_16x16x32_bf16 v[248:251], a[156:159], a[228:231], v[248:251]
    s_barrier
    v_mfma_f32_16x16x32_bf16 v[220:223], a[140:143], a[232:235], v[220:223]
    ds_read_b64_tr_b16 a[20:21], v1 offset:61440
    v_mfma_f32_16x16x32_bf16 v[228:231], a[144:147], a[232:235], v[228:231]
    ds_read_b64_tr_b16 a[22:23], v1 offset:64000
    v_mfma_f32_16x16x32_bf16 v[236:239], a[148:151], a[232:235], v[236:239]
    buffer_load_dwordx4 v20, s[24:27], s48 offen offset:3072 lds
    v_mfma_f32_16x16x32_bf16 v[244:247], a[152:155], a[232:235], v[244:247]
    ds_read_b64_tr_b16 a[24:25], v2 offset:61440
    v_mfma_f32_16x16x32_bf16 v[252:255], a[156:159], a[232:235], v[252:255]
    s_waitcnt lgkmcnt(7)
    ds_read_b64_tr_b16 a[26:27], v2 offset:64000
    v_mfma_f32_16x16x32_bf16 v[96:99], a[120:123], a[200:203], v[96:99]
    s_add_u32 m0, s42, 24576
    ds_read_b64_tr_b16 a[28:29], v3 offset:61440
    v_mfma_f32_16x16x32_bf16 v[104:107], a[124:127], a[200:203], v[104:107]
    buffer_load_dwordx4 v21, s[24:27], s48 offen lds
    v_mfma_f32_16x16x32_bf16 v[112:115], a[128:131], a[200:203], v[112:115]
    ds_read_b64_tr_b16 a[30:31], v3 offset:64000
    v_mfma_f32_16x16x32_bf16 v[120:123], a[132:135], a[200:203], v[120:123]
    ds_read_b64_tr_b16 a[32:33], v4 offset:61440
    v_mfma_f32_16x16x32_bf16 v[128:131], a[136:139], a[200:203], v[128:131]
    s_waitcnt lgkmcnt(8)
    s_add_u32 m0, s42, 40960
    ds_read_b64_tr_b16 a[34:35], v4 offset:64000
    v_mfma_f32_16x16x32_bf16 v[100:103], a[120:123], a[204:207], v[100:103]
    s_mov_b32 s48, 20480
    buffer_load_dwordx4 v17, s[24:27], s48 offen lds
    v_mfma_f32_16x16x32_bf16 v[108:111], a[124:127], a[204:207], v[108:111]
    ds_read_b64_tr_b16 a[36:37], v5 offset:61440
    ds_read_b64_tr_b16 a[224:225], v8 offset:53248
    v_mfma_f32_16x16x32_bf16 v[116:119], a[128:131], a[204:207], v[116:119]
    ds_read_b64_tr_b16 a[38:39], v5 offset:64000
    ds_read_b64_tr_b16 a[226:227], v8 offset:53760
    v_mfma_f32_16x16x32_bf16 v[124:127], a[132:135], a[204:207], v[124:127]
    ds_read_b64_tr_b16 a[216:217], v6 offset:53248
    v_mfma_f32_16x16x32_bf16 v[132:135], a[136:139], a[204:207], v[132:135]
    buffer_load_dwordx4 v18, s[24:27], s48 offen offset:1024 lds
    v_fma_f32 v96, v96, v26, v56
    v_mfma_f32_16x16x32_bf16 v[136:139], a[120:123], a[208:211], v[136:139]
    ds_read_b64_tr_b16 a[218:219], v6 offset:53760
    v_fma_f32 v97, v97, v26, v57
    v_mfma_f32_16x16x32_bf16 v[144:147], a[124:127], a[208:211], v[144:147]
    ds_read_b64_tr_b16 a[220:221], v7 offset:53248
    ds_read_b64_tr_b16 a[228:229], v9 offset:53248
    v_mfma_f32_16x16x32_bf16 v[152:155], a[128:131], a[208:211], v[152:155]
    ds_read_b64_tr_b16 a[222:223], v7 offset:53760
    ds_read_b64_tr_b16 a[230:231], v9 offset:53760
    v_mfma_f32_16x16x32_bf16 v[160:163], a[132:135], a[208:211], v[160:163]
    s_waitcnt vmcnt(7) lgkmcnt(7)
    buffer_load_dwordx4 v19, s[24:27], s48 offen offset:2048 lds
    v_fma_f32 v98, v98, v26, v58
    v_mfma_f32_16x16x32_bf16 v[168:171], a[136:139], a[208:211], v[168:171]
    s_barrier
    v_mfma_f32_16x16x32_bf16 v[140:143], a[120:123], a[212:215], v[140:143]
    ds_read_b64_tr_b16 a[40:41], v1 offset:0
    v_mfma_f32_16x16x32_bf16 v[148:151], a[124:127], a[212:215], v[148:151]
    ds_read_b64_tr_b16 a[42:43], v1 offset:2560
    v_mfma_f32_16x16x32_bf16 v[156:159], a[128:131], a[212:215], v[156:159]
    buffer_load_dwordx4 v20, s[24:27], s48 offen offset:3072 lds
    v_mfma_f32_16x16x32_bf16 v[164:167], a[132:135], a[212:215], v[164:167]
    ds_read_b64_tr_b16 a[44:45], v2 offset:0
    v_mfma_f32_16x16x32_bf16 v[172:175], a[136:139], a[212:215], v[172:175]
    s_waitcnt lgkmcnt(7)
    ds_read_b64_tr_b16 a[46:47], v2 offset:2560
    v_mfma_f32_16x16x32_bf16 v[176:179], a[120:123], a[216:219], v[176:179]
    s_add_u32 m0, s42, 45056
    ds_read_b64_tr_b16 a[48:49], v3 offset:0
    v_mfma_f32_16x16x32_bf16 v[184:187], a[124:127], a[216:219], v[184:187]
    buffer_load_dwordx4 v21, s[24:27], s48 offen lds
    v_mfma_f32_16x16x32_bf16 v[192:195], a[128:131], a[216:219], v[192:195]
    ds_read_b64_tr_b16 a[50:51], v3 offset:2560
    v_fma_f32 v99, v99, v26, v59
    v_mfma_f32_16x16x32_bf16 v[200:203], a[132:135], a[216:219], v[200:203]
    ds_read_b64_tr_b16 a[52:53], v4 offset:0
    v_mfma_f32_16x16x32_bf16 v[208:211], a[136:139], a[216:219], v[208:211]
    s_waitcnt lgkmcnt(8)
    s_add_u32 m0, s42, 61440
    ds_read_b64_tr_b16 a[54:55], v4 offset:2560
    v_mfma_f32_16x16x32_bf16 v[180:183], a[120:123], a[220:223], v[180:183]
    s_mov_b32 s48, 122880
    buffer_load_dwordx4 v17, s[24:27], s48 offen lds
    v_mfma_f32_16x16x32_bf16 v[188:191], a[124:127], a[220:223], v[188:191]
    ds_read_b64_tr_b16 a[56:57], v5 offset:0
    v_mfma_f32_16x16x32_bf16 v[196:199], a[128:131], a[220:223], v[196:199]
    ds_read_b64_tr_b16 a[58:59], v5 offset:2560
    v_mfma_f32_16x16x32_bf16 v[204:207], a[132:135], a[220:223], v[204:207]
    v_exp_f32 v32, v96
    v_mfma_f32_16x16x32_bf16 v[212:215], a[136:139], a[220:223], v[212:215]
    buffer_load_dwordx4 v18, s[24:27], s48 offen offset:1024 lds
    v_fma_f32 v32, v32, v30, v30
    v_mfma_f32_16x16x32_bf16 v[216:219], a[120:123], a[224:227], v[216:219]
    v_exp_f32 v33, v97
    v_mfma_f32_16x16x32_bf16 v[224:227], a[124:127], a[224:227], v[224:227]
    v_exp_f32 v34, v98
    v_mfma_f32_16x16x32_bf16 v[232:235], a[128:131], a[224:227], v[232:235]
    v_exp_f32 v35, v99
    v_mfma_f32_16x16x32_bf16 v[240:243], a[132:135], a[224:227], v[240:243]
    s_waitcnt vmcnt(7) lgkmcnt(0)
    buffer_load_dwordx4 v19, s[24:27], s48 offen offset:2048 lds
    v_fma_f32 v33, v33, v30, v30
    v_mfma_f32_16x16x32_bf16 v[248:251], a[136:139], a[224:227], v[248:251]
    s_barrier
    v_mfma_f32_16x16x32_bf16 v[220:223], a[120:123], a[228:231], v[220:223]
    ds_read_b64_tr_b16 a[60:61], v1 offset:20480
    v_mfma_f32_16x16x32_bf16 v[228:231], a[124:127], a[228:231], v[228:231]
    ds_read_b64_tr_b16 a[62:63], v1 offset:23040
    v_mfma_f32_16x16x32_bf16 v[236:239], a[128:131], a[228:231], v[236:239]
    buffer_load_dwordx4 v20, s[24:27], s48 offen offset:3072 lds
    v_mfma_f32_16x16x32_bf16 v[244:247], a[132:135], a[228:231], v[244:247]
    ds_read_b64_tr_b16 a[64:65], v2 offset:20480
    v_mfma_f32_16x16x32_bf16 v[252:255], a[136:139], a[228:231], v[252:255]
    ds_read_b64_tr_b16 a[66:67], v2 offset:23040
    v_fma_f32 v34, v34, v30, v30
    v_fma_f32 v35, v35, v30, v30
    v_rcp_f32 v32, v32
    v_rcp_f32 v33, v33
    v_rcp_f32 v34, v34
    v_rcp_f32 v35, v35
    v_mul_f32 v32, v96, v32
    v_mul_f32 v33, v97, v33
    v_mul_f32 v34, v98, v34
    v_mul_f32 v35, v99, v35
    v_cvt_pk_bf16_f32 v96, v32, v33
    v_cvt_pk_bf16_f32 v97, v34, v35
    s_add_u32 m0, s42, 65536
    ds_read_b64_tr_b16 a[68:69], v3 offset:20480
    v_pk_fma_f32 v[104:105], v[104:105], v[26:27], v[60:61]
    v_pk_fma_f32 v[106:107], v[106:107], v[26:27], v[62:63]
    v_exp_f32 v36, v104
    v_exp_f32 v37, v105
    v_exp_f32 v38, v106
    v_exp_f32 v39, v107
    v_pk_fma_f32 v[36:37], v[36:37], v[30:31], v[30:31]
    buffer_load_dwordx4 v21, s[24:27], s48 offen lds
    v_pk_fma_f32 v[38:39], v[38:39], v[30:31], v[30:31]
    v_rcp_f32 v36, v36
    v_rcp_f32 v37, v37
    v_rcp_f32 v38, v38
    v_rcp_f32 v39, v39
    v_pk_mul_f32 v[36:37], v[104:105], v[36:37]
    v_pk_fma_f32 v[112:113], v[112:113], v[26:27], v[64:65]
    ds_read_b64_tr_b16 a[70:71], v3 offset:23040
    v_pk_mul_f32 v[38:39], v[106:107], v[38:39]
    v_cvt_pk_bf16_f32 v104, v36, v37
    v_cvt_pk_bf16_f32 v105, v38, v39
    v_pk_fma_f32 v[114:115], v[114:115], v[26:27], v[66:67]
    v_exp_f32 v40, v112
    v_exp_f32 v41, v113
    v_exp_f32 v42, v114
    v_exp_f32 v43, v115
    ds_read_b64_tr_b16 a[72:73], v4 offset:20480
    v_pk_fma_f32 v[40:41], v[40:41], v[30:31], v[30:31]
    v_pk_fma_f32 v[42:43], v[42:43], v[30:31], v[30:31]
    v_rcp_f32 v40, v40
    v_rcp_f32 v41, v41
    v_rcp_f32 v42, v42
    v_rcp_f32 v43, v43
    v_pk_mul_f32 v[40:41], v[112:113], v[40:41]
    v_pk_fma_f32 v[120:121], v[120:121], v[26:27], v[68:69]
    s_add_u32 m0, s42, 0
    ds_read_b64_tr_b16 a[74:75], v4 offset:23040
    v_pk_mul_f32 v[42:43], v[114:115], v[42:43]
    v_cvt_pk_bf16_f32 v112, v40, v41
    v_cvt_pk_bf16_f32 v113, v42, v43
    v_pk_fma_f32 v[122:123], v[122:123], v[26:27], v[70:71]
    v_exp_f32 v44, v120
    v_exp_f32 v45, v121
    v_exp_f32 v46, v122
    v_pk_fma_f32 v[128:129], v[128:129], v[26:27], v[72:73]
    s_mov_b32 s48, 30720
    buffer_load_dwordx4 v17, s[24:27], s48 offen lds
    v_exp_f32 v47, v123
    v_pk_fma_f32 v[44:45], v[44:45], v[30:31], v[30:31]
    v_pk_fma_f32 v[130:131], v[130:131], v[26:27], v[74:75]
    v_rcp_f32 v44, v44
    v_pk_fma_f32 v[46:47], v[46:47], v[30:31], v[30:31]
    v_rcp_f32 v45, v45
    v_rcp_f32 v46, v46
    buffer_load_dwordx4 v18, s[24:27], s48 offen offset:1024 lds
    v_rcp_f32 v47, v47
    v_pk_mul_f32 v[44:45], v[120:121], v[44:45]
    v_exp_f32 v48, v128
    v_pk_mul_f32 v[46:47], v[122:123], v[46:47]
    v_cvt_pk_bf16_f32 v120, v44, v45
    v_cvt_pk_bf16_f32 v121, v46, v47
    v_exp_f32 v49, v129
    v_exp_f32 v50, v130
    buffer_load_dwordx4 v19, s[24:27], s48 offen offset:2048 lds
    v_exp_f32 v51, v131
    v_pk_fma_f32 v[48:49], v[48:49], v[30:31], v[30:31]
    v_pk_fma_f32 v[100:101], v[100:101], v[26:27], v[56:57]
    v_rcp_f32 v48, v48
    v_pk_fma_f32 v[50:51], v[50:51], v[30:31], v[30:31]
    v_rcp_f32 v49, v49
    v_rcp_f32 v50, v50
    v_pk_fma_f32 v[102:103], v[102:103], v[26:27], v[58:59]
    buffer_load_dwordx4 v20, s[24:27], s48 offen offset:3072 lds
    v_rcp_f32 v51, v51
    v_pk_mul_f32 v[48:49], v[128:129], v[48:49]
    v_exp_f32 v52, v100
    v_pk_mul_f32 v[50:51], v[130:131], v[50:51]
    v_cvt_pk_bf16_f32 v128, v48, v49
    v_cvt_pk_bf16_f32 v129, v50, v51
    v_exp_f32 v53, v101
    v_pk_fma_f32 v[108:109], v[108:109], v[26:27], v[60:61]
    s_add_u32 m0, s42, 4096
    s_nop 0
    buffer_load_dwordx4 v21, s[24:27], s48 offen lds
    v_exp_f32 v54, v102
    v_exp_f32 v55, v103
    v_pk_fma_f32 v[52:53], v[52:53], v[30:31], v[30:31]
    v_pk_fma_f32 v[110:111], v[110:111], v[26:27], v[62:63]
    v_rcp_f32 v52, v52
    v_pk_fma_f32 v[54:55], v[54:55], v[30:31], v[30:31]
    v_rcp_f32 v53, v53
    ds_read_b64_tr_b16 a[76:77], v5 offset:20480
    v_rcp_f32 v54, v54
    v_rcp_f32 v55, v55
    v_pk_mul_f32 v[52:53], v[100:101], v[52:53]
    v_exp_f32 v32, v108
    v_pk_mul_f32 v[54:55], v[102:103], v[54:55]
    v_cvt_pk_bf16_f32 v100, v52, v53
    v_cvt_pk_bf16_f32 v101, v54, v55
    v_exp_f32 v33, v109
    ds_read_b64_tr_b16 a[78:79], v5 offset:23040
    v_exp_f32 v34, v110
    v_exp_f32 v35, v111
    v_pk_fma_f32 v[32:33], v[32:33], v[30:31], v[30:31]
    v_pk_fma_f32 v[116:117], v[116:117], v[26:27], v[64:65]
    v_rcp_f32 v32, v32
    v_pk_fma_f32 v[34:35], v[34:35], v[30:31], v[30:31]
    v_rcp_f32 v33, v33
    v_pk_fma_f32 v[118:119], v[118:119], v[26:27], v[66:67]
    v_rcp_f32 v34, v34
    v_rcp_f32 v35, v35
    v_pk_mul_f32 v[32:33], v[108:109], v[32:33]
    v_exp_f32 v36, v116
    v_pk_mul_f32 v[34:35], v[110:111], v[34:35]
    v_cvt_pk_bf16_f32 v108, v32, v33
    v_cvt_pk_bf16_f32 v109, v34, v35
    v_pk_fma_f32 v[124:125], v[124:125], v[26:27], v[68:69]
    v_exp_f32 v37, v117
    v_exp_f32 v38, v118
    v_exp_f32 v39, v119
    v_pk_fma_f32 v[36:37], v[36:37], v[30:31], v[30:31]
    v_pk_fma_f32 v[126:127], v[126:127], v[26:27], v[70:71]
    v_rcp_f32 v36, v36
    v_pk_fma_f32 v[38:39], v[38:39], v[30:31], v[30:31]
    v_rcp_f32 v37, v37
    v_rcp_f32 v38, v38
    v_rcp_f32 v39, v39
    v_pk_mul_f32 v[36:37], v[116:117], v[36:37]
    v_exp_f32 v40, v124
    v_pk_mul_f32 v[38:39], v[118:119], v[38:39]
    v_cvt_pk_bf16_f32 v116, v36, v37
    v_cvt_pk_bf16_f32 v117, v38, v39
    v_exp_f32 v41, v125
    v_exp_f32 v42, v126
    v_exp_f32 v43, v127
    v_pk_fma_f32 v[40:41], v[40:41], v[30:31], v[30:31]
    v_pk_fma_f32 v[132:133], v[132:133], v[26:27], v[72:73]
    v_rcp_f32 v40, v40
    v_pk_fma_f32 v[42:43], v[42:43], v[30:31], v[30:31]
    v_pk_fma_f32 v[134:135], v[134:135], v[26:27], v[74:75]
    ds_write_b64 v16, v[96:97] offset:0
    ds_write_b64 v16, v[104:105] offset:8192
    ds_write_b64 v16, v[112:113] offset:16384
    ds_write_b64 v16, v[120:121] offset:24576
    ds_write_b64 v16, v[128:129] offset:32768
    ds_write_b64 v16, v[100:101] offset:256
    ds_write_b64 v16, v[108:109] offset:8448
    ds_write_b64 v16, v[116:117] offset:16640
    v_rcp_f32 v41, v41
    v_rcp_f32 v42, v42
    v_rcp_f32 v43, v43
    v_pk_mul_f32 v[40:41], v[124:125], v[40:41]
    v_exp_f32 v44, v132
    v_pk_mul_f32 v[42:43], v[126:127], v[42:43]
    v_cvt_pk_bf16_f32 v124, v40, v41
    v_cvt_pk_bf16_f32 v125, v42, v43
    v_exp_f32 v45, v133
    v_exp_f32 v46, v134
    v_exp_f32 v47, v135
    v_pk_fma_f32 v[44:45], v[44:45], v[30:31], v[30:31]
    v_pk_fma_f32 v[136:137], v[136:137], v[26:27], v[56:57]
    v_rcp_f32 v44, v44
    v_pk_fma_f32 v[46:47], v[46:47], v[30:31], v[30:31]
    v_rcp_f32 v45, v45
    v_rcp_f32 v46, v46
    v_rcp_f32 v47, v47
    v_pk_mul_f32 v[44:45], v[132:133], v[44:45]
    v_pk_fma_f32 v[138:139], v[138:139], v[26:27], v[58:59]
    v_cvt_pk_bf16_f32 v132, v44, v45
    v_pk_mul_f32 v[46:47], v[134:135], v[46:47]
    v_pk_fma_f32 v[144:145], v[144:145], v[26:27], v[60:61]
    ds_write_b64 v16, v[124:125] offset:24832
    v_cvt_pk_bf16_f32 v133, v46, v47
    v_exp_f32 v48, v136
    v_exp_f32 v49, v137
    v_exp_f32 v50, v138
    v_exp_f32 v51, v139
    v_pk_fma_f32 v[48:49], v[48:49], v[30:31], v[30:31]
    v_exp_f32 v52, v144
    v_pk_fma_f32 v[50:51], v[50:51], v[30:31], v[30:31]
    v_rcp_f32 v48, v48
    v_rcp_f32 v49, v49
    v_rcp_f32 v50, v50
    v_rcp_f32 v51, v51
    v_pk_mul_f32 v[48:49], v[136:137], v[48:49]
    v_pk_fma_f32 v[146:147], v[146:147], v[26:27], v[62:63]
    v_cvt_pk_bf16_f32 v136, v48, v49
    v_pk_mul_f32 v[50:51], v[138:139], v[50:51]
    v_exp_f32 v53, v145
    v_cvt_pk_bf16_f32 v137, v50, v51
    v_exp_f32 v54, v146
    v_exp_f32 v55, v147
    v_pk_fma_f32 v[52:53], v[52:53], v[30:31], v[30:31]
    ds_write_b64 v16, v[132:133] offset:33024
    ds_write_b64 v16, v[136:137] offset:512
    v_pk_fma_f32 v[54:55], v[54:55], v[30:31], v[30:31]
    v_rcp_f32 v52, v52
    v_rcp_f32 v53, v53
    v_rcp_f32 v54, v54
    v_rcp_f32 v55, v55
    v_pk_mul_f32 v[52:53], v[144:145], v[52:53]
    v_pk_mul_f32 v[54:55], v[146:147], v[54:55]
    v_cvt_pk_bf16_f32 v144, v52, v53
    v_cvt_pk_bf16_f32 v145, v54, v55
    v_add_u32 v10, 40960, v10
    v_add_u32 v11, 40960, v11
    v_add_u32 v12, 40960, v12
    v_add_u32 v13, 40960, v13
    v_add_u32 v6, 81920, v14
    v_add_u32 v7, 81920, v15
    s_waitcnt vmcnt(0) lgkmcnt(1)
    s_barrier
    v_mfma_f32_16x16x16_bf16 v[96:99], a[236:237], v[24:25], 0
    ds_read_b64_tr_b16 a[80:81], v1 offset:40960
    ds_read_b64_tr_b16 a[82:83], v1 offset:43520
    ds_read_b64_tr_b16 a[138:139], v5 offset:2560
    v_mfma_f32_16x16x16_bf16 v[100:103], a[238:239], v[24:25], 0
    s_add_u32 m0, s42, 20480
    ds_read_b64_tr_b16 a[84:85], v2 offset:40960
    ds_read_b64_tr_b16 a[86:87], v2 offset:43520
    ds_read_b128 a[232:235], v14 offset:0
    v_mfma_f32_16x16x16_bf16 v[104:107], a[240:241], v[24:25], 0
    s_mov_b32 s48, 133120
    ds_read_b64_tr_b16 a[88:89], v3 offset:40960
    ds_read_b128 a[200:203], v15 offset:0
    buffer_load_dwordx4 v17, s[24:27], s48 offen lds
    v_mfma_f32_16x16x16_bf16 v[108:111], a[242:243], v[24:25], 0
    ds_read_b64_tr_b16 a[90:91], v3 offset:43520
    ds_read_b64_tr_b16 a[92:93], v4 offset:40960
    ds_read_b128 a[204:207], v14 offset:4096
    v_mfma_f32_16x16x16_bf16 v[112:115], a[244:245], v[24:25], 0
    ds_read_b64_tr_b16 a[94:95], v4 offset:43520
    ds_read_b64_tr_b16 a[96:97], v5 offset:40960
    v_mfma_f32_16x16x16_bf16 v[116:119], a[246:247], v[24:25], 0
    ds_read_b64_tr_b16 a[98:99], v5 offset:43520
    buffer_load_dwordx4 v18, s[24:27], s48 offen offset:1024 lds
    v_mfma_f32_16x16x16_bf16 v[120:123], a[248:249], v[24:25], 0
    ds_read_b64_tr_b16 a[100:101], v1 offset:61440
    ds_read_b64_tr_b16 a[102:103], v1 offset:64000
    v_mfma_f32_16x16x16_bf16 v[124:127], a[250:251], v[24:25], 0
    ds_read_b64_tr_b16 a[104:105], v2 offset:61440
    ds_read_b64_tr_b16 a[106:107], v2 offset:64000
    v_pk_fma_f32 v[152:153], v[152:153], v[26:27], v[64:65]
    v_pk_fma_f32 v[154:155], v[154:155], v[26:27], v[66:67]
    v_pk_fma_f32 v[160:161], v[160:161], v[26:27], v[68:69]
    v_pk_fma_f32 v[162:163], v[162:163], v[26:27], v[70:71]
    v_pk_fma_f32 v[168:169], v[168:169], v[26:27], v[72:73]
    v_pk_fma_f32 v[170:171], v[170:171], v[26:27], v[74:75]
    v_pk_fma_f32 v[140:141], v[140:141], v[26:27], v[56:57]
    v_pk_fma_f32 v[142:143], v[142:143], v[26:27], v[58:59]
    v_pk_fma_f32 v[148:149], v[148:149], v[26:27], v[60:61]
    v_pk_fma_f32 v[150:151], v[150:151], v[26:27], v[62:63]
    v_pk_fma_f32 v[156:157], v[156:157], v[26:27], v[64:65]
    v_pk_fma_f32 v[158:159], v[158:159], v[26:27], v[66:67]
    v_exp_f32 v32, v152
    v_mfma_f32_16x16x16_bf16 v[128:131], a[252:253], v[24:25], 0
    ds_read_b64_tr_b16 a[108:109], v3 offset:61440
    buffer_load_dwordx4 v19, s[24:27], s48 offen offset:2048 lds
    v_exp_f32 v33, v153
    v_mfma_f32_16x16x16_bf16 v[132:135], a[254:255], v[24:25], 0
    s_waitcnt lgkmcnt(13)
    ds_read_b64_tr_b16 a[110:111], v3 offset:64000
    ds_read_b64_tr_b16 a[112:113], v4 offset:61440
    v_exp_f32 v34, v154
    v_mfma_f32_16x16x32_bf16 v[96:99], a[232:235], a[0:3], v[96:99]
    ds_read_b64_tr_b16 a[114:115], v4 offset:64000
    ds_read_b64_tr_b16 a[116:117], v5 offset:61440
    v_exp_f32 v35, v155
    v_mfma_f32_16x16x32_bf16 v[104:107], a[232:235], a[4:7], v[104:107]
    ds_read_b64_tr_b16 a[118:119], v5 offset:64000
    buffer_load_dwordx4 v20, s[24:27], s48 offen offset:3072 lds
    v_exp_f32 v36, v160
    v_mfma_f32_16x16x32_bf16 v[112:115], a[232:235], a[8:11], v[112:115]
    ds_read_b64_tr_b16 a[120:121], v1 offset:0
    ds_read_b64_tr_b16 a[122:123], v1 offset:2560
    v_exp_f32 v37, v161
    v_mfma_f32_16x16x32_bf16 v[120:123], a[232:235], a[12:15], v[120:123]
    s_add_u32 m0, s42, 24576
    ds_read_b64_tr_b16 a[124:125], v2 offset:0
    ds_read_b64_tr_b16 a[126:127], v2 offset:2560
    v_exp_f32 v38, v162
    v_mfma_f32_16x16x32_bf16 v[128:131], a[232:235], a[16:19], v[128:131]
    s_waitcnt lgkmcnt(15)
    ds_read_b64_tr_b16 a[128:129], v3 offset:0
    buffer_load_dwordx4 v21, s[24:27], s48 offen lds
    v_exp_f32 v39, v163
    v_mfma_f32_16x16x32_bf16 v[100:103], a[200:203], a[0:3], v[100:103]
    ds_read_b64_tr_b16 a[130:131], v3 offset:2560
    ds_read_b64_tr_b16 a[132:133], v4 offset:0
    v_exp_f32 v40, v168
    v_exp_f32 v41, v169
    v_pk_fma_f32 v[32:33], v[32:33], v[30:31], v[30:31]
    v_pk_fma_f32 v[34:35], v[34:35], v[30:31], v[30:31]
    v_pk_fma_f32 v[36:37], v[36:37], v[30:31], v[30:31]
    v_pk_fma_f32 v[38:39], v[38:39], v[30:31], v[30:31]
    v_pk_fma_f32 v[40:41], v[40:41], v[30:31], v[30:31]
    v_pk_fma_f32 v[164:165], v[164:165], v[26:27], v[68:69]
    v_pk_fma_f32 v[166:167], v[166:167], v[26:27], v[70:71]
    v_rcp_f32 v32, v32
    v_mfma_f32_16x16x32_bf16 v[108:111], a[200:203], a[4:7], v[108:111]
    ds_read_b64_tr_b16 a[134:135], v4 offset:2560
    ds_read_b64_tr_b16 a[136:137], v5 offset:0
    v_rcp_f32 v33, v33
    v_mfma_f32_16x16x32_bf16 v[116:119], a[200:203], a[8:11], v[116:119]
    ds_read_b128 a[208:211], v15 offset:4096
    ds_read_b128 a[212:215], v14 offset:8192
    v_rcp_f32 v34, v34
    v_mfma_f32_16x16x32_bf16 v[124:127], a[200:203], a[12:15], v[124:127]
    ds_write_b64 v16, v[144:145] offset:8704
    ds_read_b128 a[216:219], v15 offset:8192
    v_rcp_f32 v35, v35
    v_mfma_f32_16x16x32_bf16 v[132:135], a[200:203], a[16:19], v[132:135]
    ds_read_b128 a[220:223], v14 offset:12288
    v_rcp_f32 v36, v36
    v_mfma_f32_16x16x32_bf16 v[96:99], a[204:207], a[20:23], v[96:99]
    s_waitcnt lgkmcnt(5)
    ds_read_b128 a[224:227], v15 offset:12288
    v_rcp_f32 v37, v37
    v_mfma_f32_16x16x32_bf16 v[104:107], a[204:207], a[24:27], v[104:107]
    s_barrier
    v_mfma_f32_16x16x32_bf16 v[112:115], a[204:207], a[28:31], v[112:115]
    ds_read_b128 a[228:231], v14 offset:16384
    v_mfma_f32_16x16x32_bf16 v[120:123], a[204:207], a[32:35], v[120:123]
    s_add_u32 m0, s42, 40960
    v_mfma_f32_16x16x32_bf16 v[128:131], a[204:207], a[36:39], v[128:131]
    s_waitcnt lgkmcnt(6)
    s_mov_b32 s48, 40960
    buffer_load_dwordx4 v17, s[24:27], s48 offen lds
    v_mfma_f32_16x16x32_bf16 v[100:103], a[208:211], a[20:23], v[100:103]
    v_mfma_f32_16x16x32_bf16 v[108:111], a[208:211], a[24:27], v[108:111]
    ds_read_b128 a[232:235], v15 offset:16384
    v_mfma_f32_16x16x32_bf16 v[116:119], a[208:211], a[28:31], v[116:119]
    buffer_load_dwordx4 v18, s[24:27], s48 offen offset:1024 lds
    v_mfma_f32_16x16x32_bf16 v[124:127], a[208:211], a[32:35], v[124:127]
    v_mfma_f32_16x16x32_bf16 v[132:135], a[208:211], a[36:39], v[132:135]
    s_waitcnt lgkmcnt(6)
    v_rcp_f32 v38, v38
    v_rcp_f32 v39, v39
    v_exp_f32 v42, v170
    v_pk_mul_f32 v[32:33], v[152:153], v[32:33]
    v_pk_mul_f32 v[34:35], v[154:155], v[34:35]
    v_pk_mul_f32 v[36:37], v[160:161], v[36:37]
    v_pk_mul_f32 v[38:39], v[162:163], v[38:39]
    v_pk_fma_f32 v[172:173], v[172:173], v[26:27], v[72:73]
    v_pk_fma_f32 v[174:175], v[174:175], v[26:27], v[74:75]
    v_cvt_pk_bf16_f32 v152, v32, v33
    v_mfma_f32_16x16x32_bf16 v[96:99], a[212:215], a[40:43], v[96:99]
    buffer_load_dwordx4 v19, s[24:27], s48 offen offset:2048 lds
    v_cvt_pk_bf16_f32 v153, v34, v35
    v_exp_f32 v43, v171
    v_mfma_f32_16x16x32_bf16 v[104:107], a[212:215], a[44:47], v[104:107]
    ds_read_b128 a[200:203], v14 offset:20480
    v_rcp_f32 v40, v40
    v_mfma_f32_16x16x32_bf16 v[112:115], a[212:215], a[48:51], v[112:115]
    v_cvt_pk_bf16_f32 v160, v36, v37
    v_rcp_f32 v41, v41
    v_mfma_f32_16x16x32_bf16 v[120:123], a[212:215], a[52:55], v[120:123]
    buffer_load_dwordx4 v20, s[24:27], s48 offen offset:3072 lds
    v_exp_f32 v44, v140
    v_mfma_f32_16x16x32_bf16 v[128:131], a[212:215], a[56:59], v[128:131]
    s_waitcnt lgkmcnt(5)
    v_cvt_pk_bf16_f32 v161, v38, v39
    v_exp_f32 v45, v141
    v_mfma_f32_16x16x32_bf16 v[100:103], a[216:219], a[40:43], v[100:103]
    s_add_u32 m0, s42, 45056
    v_exp_f32 v46, v142
    v_mfma_f32_16x16x32_bf16 v[108:111], a[216:219], a[44:47], v[108:111]
    buffer_load_dwordx4 v21, s[24:27], s48 offen lds
    v_exp_f32 v47, v143
    v_mfma_f32_16x16x32_bf16 v[116:119], a[216:219], a[48:51], v[116:119]
    ds_read_b128 a[204:207], v15 offset:20480
    v_exp_f32 v48, v148
    v_exp_f32 v49, v149
    v_pk_fma_f32 v[42:43], v[42:43], v[30:31], v[30:31]
    v_pk_mul_f32 v[40:41], v[168:169], v[40:41]
    v_pk_fma_f32 v[44:45], v[44:45], v[30:31], v[30:31]
    v_pk_fma_f32 v[46:47], v[46:47], v[30:31], v[30:31]
    v_pk_fma_f32 v[48:49], v[48:49], v[30:31], v[30:31]
    v_pk_fma_f32 v[176:177], v[176:177], v[26:27], v[56:57]
    v_pk_fma_f32 v[178:179], v[178:179], v[26:27], v[58:59]
    v_cvt_pk_bf16_f32 v168, v40, v41
    v_mfma_f32_16x16x32_bf16 v[124:127], a[216:219], a[52:55], v[124:127]
    v_rcp_f32 v42, v42
    v_mfma_f32_16x16x32_bf16 v[132:135], a[216:219], a[56:59], v[132:135]
    s_waitcnt lgkmcnt(5)
    s_add_u32 m0, s42, 61440
    v_rcp_f32 v43, v43
    v_mfma_f32_16x16x32_bf16 v[96:99], a[220:223], a[60:63], v[96:99]
    s_mov_b32 s48, 143360
    ds_write_b64 v16, v[152:153] offset:16896
    buffer_load_dwordx4 v17, s[24:27], s48 offen lds
    v_mfma_f32_16x16x32_bf16 v[104:107], a[220:223], a[64:67], v[104:107]
    ds_read_b128 a[208:211], v14 offset:24576
    v_rcp_f32 v44, v44
    v_mfma_f32_16x16x32_bf16 v[112:115], a[220:223], a[68:71], v[112:115]
    v_rcp_f32 v45, v45
    v_mfma_f32_16x16x32_bf16 v[120:123], a[220:223], a[72:75], v[120:123]
    buffer_load_dwordx4 v18, s[24:27], s48 offen offset:1024 lds
    v_rcp_f32 v46, v46
    v_mfma_f32_16x16x32_bf16 v[128:131], a[220:223], a[76:79], v[128:131]
    s_waitcnt lgkmcnt(6)
    v_rcp_f32 v47, v47
    v_mfma_f32_16x16x32_bf16 v[100:103], a[224:227], a[60:63], v[100:103]
    v_exp_f32 v50, v150
    v_exp_f32 v51, v151
    v_rcp_f32 v48, v48
    v_pk_mul_f32 v[42:43], v[170:171], v[42:43]
    v_pk_mul_f32 v[44:45], v[140:141], v[44:45]
    v_pk_mul_f32 v[46:47], v[142:143], v[46:47]
    v_pk_fma_f32 v[50:51], v[50:51], v[30:31], v[30:31]
    v_pk_fma_f32 v[184:185], v[184:185], v[26:27], v[60:61]
    v_pk_fma_f32 v[186:187], v[186:187], v[26:27], v[62:63]
    v_cvt_pk_bf16_f32 v169, v42, v43
    v_mfma_f32_16x16x32_bf16 v[108:111], a[224:227], a[64:67], v[108:111]
    buffer_load_dwordx4 v19, s[24:27], s48 offen offset:2048 lds
    v_rcp_f32 v49, v49
    v_mfma_f32_16x16x32_bf16 v[116:119], a[224:227], a[68:71], v[116:119]
    ds_read_b128 a[212:215], v15 offset:24576
    v_rcp_f32 v50, v50
    v_mfma_f32_16x16x32_bf16 v[124:127], a[224:227], a[72:75], v[124:127]
    v_cvt_pk_bf16_f32 v140, v44, v45
    v_rcp_f32 v51, v51
    v_mfma_f32_16x16x32_bf16 v[132:135], a[224:227], a[76:79], v[132:135]
    s_waitcnt lgkmcnt(6)
    buffer_load_dwordx4 v20, s[24:27], s48 offen offset:3072 lds
    v_exp_f32 v52, v156
    v_mfma_f32_16x16x32_bf16 v[96:99], a[228:231], a[80:83], v[96:99]
    v_cvt_pk_bf16_f32 v141, v46, v47
    v_exp_f32 v53, v157
    v_mfma_f32_16x16x32_bf16 v[104:107], a[228:231], a[84:87], v[104:107]
    s_add_u32 m0, s42, 65536
    ds_read_b128 a[216:219], v14 offset:28672
    v_exp_f32 v54, v158
    v_mfma_f32_16x16x32_bf16 v[112:115], a[228:231], a[88:91], v[112:115]
    buffer_load_dwordx4 v21, s[24:27], s48 offen lds
    v_exp_f32 v55, v159
    v_mfma_f32_16x16x32_bf16 v[120:123], a[228:231], a[92:95], v[120:123]
    v_exp_f32 v32, v164
    v_exp_f32 v33, v165
    v_exp_f32 v34, v166
    v_pk_mul_f32 v[48:49], v[148:149], v[48:49]
    v_pk_mul_f32 v[50:51], v[150:151], v[50:51]
    v_pk_fma_f32 v[52:53], v[52:53], v[30:31], v[30:31]
    v_pk_fma_f32 v[54:55], v[54:55], v[30:31], v[30:31]
    v_pk_fma_f32 v[32:33], v[32:33], v[30:31], v[30:31]
    v_pk_fma_f32 v[192:193], v[192:193], v[26:27], v[64:65]
    v_pk_fma_f32 v[194:195], v[194:195], v[26:27], v[66:67]
    v_cvt_pk_bf16_f32 v148, v48, v49
    v_mfma_f32_16x16x32_bf16 v[128:131], a[228:231], a[96:99], v[128:131]
    s_waitcnt lgkmcnt(6)
    v_cvt_pk_bf16_f32 v149, v50, v51
    v_rcp_f32 v52, v52
    v_mfma_f32_16x16x32_bf16 v[100:103], a[232:235], a[80:83], v[100:103]
    v_rcp_f32 v53, v53
    v_mfma_f32_16x16x32_bf16 v[108:111], a[232:235], a[84:87], v[108:111]
    ds_write_b64 v16, v[160:161] offset:25088
    ds_read_b128 a[220:223], v15 offset:28672
    v_mfma_f32_16x16x32_bf16 v[116:119], a[232:235], a[88:91], v[116:119]
    v_rcp_f32 v54, v54
    v_mfma_f32_16x16x32_bf16 v[124:127], a[232:235], a[92:95], v[124:127]
    ds_write_b64 v16, v[168:169] offset:33280
    v_mfma_f32_16x16x32_bf16 v[132:135], a[232:235], a[96:99], v[132:135]
    s_waitcnt lgkmcnt(8)
    v_rcp_f32 v55, v55
    v_mfma_f32_16x16x32_bf16 v[96:99], a[200:203], a[100:103], v[96:99]
    s_waitcnt vmcnt(5)
    ds_write_b64 v16, v[140:141] offset:768
    v_mfma_f32_16x16x32_bf16 v[104:107], a[200:203], a[104:107], v[104:107]
    s_barrier
    v_mfma_f32_16x16x32_bf16 v[112:115], a[200:203], a[108:111], v[112:115]
    ds_write_b64 v16, v[148:149] offset:8960
    ds_read_b64_tr_b16 a[140:141], v1 offset:20480
    ds_read_b64_tr_b16 a[142:143], v1 offset:23040
    v_mfma_f32_16x16x32_bf16 v[120:123], a[200:203], a[112:115], v[120:123]
    ds_read_b64_tr_b16 a[144:145], v2 offset:20480
    ds_read_b64_tr_b16 a[146:147], v2 offset:23040
    v_mfma_f32_16x16x32_bf16 v[128:131], a[200:203], a[116:119], v[128:131]
    s_waitcnt lgkmcnt(13)
    ds_read_b64_tr_b16 a[148:149], v3 offset:20480
    ds_read_b64_tr_b16 a[150:151], v3 offset:23040
    v_mfma_f32_16x16x32_bf16 v[100:103], a[204:207], a[100:103], v[100:103]
    ds_read_b64_tr_b16 a[152:153], v4 offset:20480
    ds_read_b64_tr_b16 a[154:155], v4 offset:23040
    v_mfma_f32_16x16x32_bf16 v[108:111], a[204:207], a[104:107], v[108:111]
    ds_read_b64_tr_b16 a[156:157], v5 offset:20480
    ds_read_b64_tr_b16 a[158:159], v5 offset:23040
    v_mfma_f32_16x16x32_bf16 v[116:119], a[204:207], a[108:111], v[116:119]
    ds_read_b64_tr_b16 a[160:161], v1 offset:40960
    ds_read_b64_tr_b16 a[162:163], v1 offset:43520
    v_mfma_f32_16x16x32_bf16 v[124:127], a[204:207], a[112:115], v[124:127]
    ds_read_b64_tr_b16 a[164:165], v2 offset:40960
    ds_read_b64_tr_b16 a[166:167], v2 offset:43520
    v_mfma_f32_16x16x32_bf16 v[132:135], a[204:207], a[116:119], v[132:135]
    s_waitcnt lgkmcnt(15)
    ds_read_b64_tr_b16 a[168:169], v3 offset:40960
    ds_read_b64_tr_b16 a[170:171], v3 offset:43520
    v_exp_f32 v35, v167
    v_rcp_f32 v32, v32
    v_pk_mul_f32 v[52:53], v[156:157], v[52:53]
    v_pk_mul_f32 v[54:55], v[158:159], v[54:55]
    v_pk_fma_f32 v[34:35], v[34:35], v[30:31], v[30:31]
    v_pk_fma_f32 v[200:201], v[200:201], v[26:27], v[68:69]
    v_pk_fma_f32 v[202:203], v[202:203], v[26:27], v[70:71]
    v_cvt_pk_bf16_f32 v156, v52, v53
    v_mfma_f32_16x16x32_bf16 v[96:99], a[208:211], a[120:123], v[96:99]
    ds_read_b64_tr_b16 a[172:173], v4 offset:40960
    ds_read_b64_tr_b16 a[174:175], v4 offset:43520
    v_cvt_pk_bf16_f32 v157, v54, v55
    v_mfma_f32_16x16x32_bf16 v[104:107], a[208:211], a[124:127], v[104:107]
    ds_read_b64_tr_b16 a[176:177], v5 offset:40960
    ds_read_b64_tr_b16 a[178:179], v5 offset:43520
    v_mfma_f32_16x16x32_bf16 v[112:115], a[208:211], a[128:131], v[112:115]
    ds_write_b64 v16, v[156:157] offset:17152
    ds_read_b128 a[224:227], v14 offset:32768
    ds_read_b128 a[228:231], v15 offset:32768
    v_mfma_f32_16x16x32_bf16 v[120:123], a[208:211], a[132:135], v[120:123]
    ds_read_b128 a[232:235], v14 offset:36864
    v_rcp_f32 v33, v33
    v_mfma_f32_16x16x32_bf16 v[128:131], a[208:211], a[136:139], v[128:131]
    v_rcp_f32 v34, v34
    v_mfma_f32_16x16x32_bf16 v[100:103], a[212:215], a[120:123], v[100:103]
    v_rcp_f32 v35, v35
    v_mfma_f32_16x16x32_bf16 v[108:111], a[212:215], a[124:127], v[108:111]
    ds_read_b128 a[200:203], v15 offset:36864
    v_exp_f32 v36, v172
    v_mfma_f32_16x16x32_bf16 v[116:119], a[212:215], a[128:131], v[116:119]
    v_exp_f32 v37, v173
    v_exp_f32 v38, v174
    v_exp_f32 v39, v175
    v_pk_mul_f32 v[32:33], v[164:165], v[32:33]
    v_pk_mul_f32 v[34:35], v[166:167], v[34:35]
    v_pk_fma_f32 v[36:37], v[36:37], v[30:31], v[30:31]
    v_pk_fma_f32 v[38:39], v[38:39], v[30:31], v[30:31]
    v_pk_fma_f32 v[208:209], v[208:209], v[26:27], v[72:73]
    v_pk_fma_f32 v[210:211], v[210:211], v[26:27], v[74:75]
    v_cvt_pk_bf16_f32 v164, v32, v33
    v_mfma_f32_16x16x32_bf16 v[124:127], a[212:215], a[132:135], v[124:127]
    v_rcp_f32 v36, v36
    v_mfma_f32_16x16x32_bf16 v[132:135], a[212:215], a[136:139], v[132:135]
    s_waitcnt lgkmcnt(15)
    v_rcp_f32 v37, v37
    v_mfma_f32_16x16x32_bf16 v[96:99], a[216:219], a[140:143], v[96:99]
    s_waitcnt vmcnt(0) lgkmcnt(5)
    v_cvt_pk_bf16_f32 v165, v34, v35
    v_rcp_f32 v38, v38
    v_rcp_f32 v39, v39
    v_pk_mul_f32 v[36:37], v[172:173], v[36:37]
    v_exp_f32 v40, v176
    v_mfma_f32_16x16x32_bf16 v[104:107], a[216:219], a[144:147], v[104:107]
    s_barrier
    v_mfma_f32_16x16x32_bf16 v[112:115], a[216:219], a[148:151], v[112:115]
    ds_write_b64 v16, v[164:165] offset:25344
    ds_read_b64_tr_b16 a[180:181], v1 offset:61440
    ds_read_b64_tr_b16 a[182:183], v1 offset:64000
    v_mfma_f32_16x16x32_bf16 v[120:123], a[216:219], a[152:155], v[120:123]
    ds_read_b64_tr_b16 a[184:185], v2 offset:61440
    ds_read_b64_tr_b16 a[186:187], v2 offset:64000
    v_mfma_f32_16x16x32_bf16 v[128:131], a[216:219], a[156:159], v[128:131]
    ds_read_b64_tr_b16 a[188:189], v3 offset:61440
    ds_read_b64_tr_b16 a[190:191], v3 offset:64000
    v_mfma_f32_16x16x32_bf16 v[100:103], a[220:223], a[140:143], v[100:103]
    ds_read_b64_tr_b16 a[192:193], v4 offset:61440
    ds_read_b64_tr_b16 a[194:195], v4 offset:64000
    v_mfma_f32_16x16x32_bf16 v[108:111], a[220:223], a[144:147], v[108:111]
    ds_read_b64_tr_b16 a[196:197], v5 offset:61440
    ds_read_b64_tr_b16 a[198:199], v5 offset:64000
    v_mfma_f32_16x16x32_bf16 v[116:119], a[220:223], a[148:151], v[116:119]
    v_mfma_f32_16x16x32_bf16 v[124:127], a[220:223], a[152:155], v[124:127]
    v_mfma_f32_16x16x32_bf16 v[132:135], a[220:223], a[156:159], v[132:135]
    s_waitcnt lgkmcnt(14)
    v_cvt_pk_bf16_f32 v172, v36, v37
    v_exp_f32 v41, v177
    v_exp_f32 v42, v178
    v_pk_mul_f32 v[38:39], v[174:175], v[38:39]
    v_pk_fma_f32 v[40:41], v[40:41], v[30:31], v[30:31]
    v_pk_fma_f32 v[180:181], v[180:181], v[26:27], v[56:57]
    v_pk_fma_f32 v[182:183], v[182:183], v[26:27], v[58:59]
    v_cvt_pk_bf16_f32 v173, v38, v39
    v_mfma_f32_16x16x32_bf16 v[96:99], a[224:227], a[160:163], v[96:99]
    ds_write_b64 v16, v[172:173] offset:33536
    v_mfma_f32_16x16x32_bf16 v[104:107], a[224:227], a[164:167], v[104:107]
    v_exp_f32 v43, v179
    v_mfma_f32_16x16x32_bf16 v[112:115], a[224:227], a[168:171], v[112:115]
    v_rcp_f32 v40, v40
    v_mfma_f32_16x16x32_bf16 v[120:123], a[224:227], a[172:175], v[120:123]
    v_rcp_f32 v41, v41
    v_mfma_f32_16x16x32_bf16 v[128:131], a[224:227], a[176:179], v[128:131]
    s_waitcnt lgkmcnt(14)
    v_exp_f32 v44, v184
    v_mfma_f32_16x16x32_bf16 v[100:103], a[228:231], a[160:163], v[100:103]
    v_exp_f32 v45, v185
    v_mfma_f32_16x16x32_bf16 v[108:111], a[228:231], a[164:167], v[108:111]
    v_exp_f32 v46, v186
    v_mfma_f32_16x16x32_bf16 v[116:119], a[228:231], a[168:171], v[116:119]
    v_exp_f32 v47, v187
    v_exp_f32 v48, v192
    v_exp_f32 v49, v193
    v_pk_fma_f32 v[42:43], v[42:43], v[30:31], v[30:31]
    v_pk_mul_f32 v[40:41], v[176:177], v[40:41]
    v_pk_fma_f32 v[44:45], v[44:45], v[30:31], v[30:31]
    v_pk_fma_f32 v[46:47], v[46:47], v[30:31], v[30:31]
    v_pk_fma_f32 v[48:49], v[48:49], v[30:31], v[30:31]
    v_cvt_pk_bf16_f32 v176, v40, v41
    v_mfma_f32_16x16x32_bf16 v[124:127], a[228:231], a[172:175], v[124:127]
    v_rcp_f32 v42, v42
    v_mfma_f32_16x16x32_bf16 v[132:135], a[228:231], a[176:179], v[132:135]
    s_waitcnt lgkmcnt(1)
    v_rcp_f32 v43, v43
    v_mfma_f32_16x16x32_bf16 v[96:99], a[232:235], a[180:183], v[96:99]
    s_waitcnt lgkmcnt(0)
    v_rcp_f32 v44, v44
    v_mfma_f32_16x16x32_bf16 v[104:107], a[232:235], a[184:187], v[104:107]
    s_barrier
    v_mfma_f32_16x16x32_bf16 v[112:115], a[232:235], a[188:191], v[112:115]
    ds_read_b128 a[204:207], v14 offset:512
    ds_read_b128 a[208:211], v15 offset:512
    v_mfma_f32_16x16x32_bf16 v[120:123], a[232:235], a[192:195], v[120:123]
    ds_read_b128 a[212:215], v14 offset:4608
    ds_read_b128 a[216:219], v15 offset:4608
    v_mfma_f32_16x16x32_bf16 v[128:131], a[232:235], a[196:199], v[128:131]
    ds_read_b128 a[220:223], v14 offset:8704
    ds_read_b128 a[224:227], v15 offset:8704
    v_mfma_f32_16x16x32_bf16 v[100:103], a[200:203], a[180:183], v[100:103]
    ds_read_b64_tr_b16 a[236:237], v10 offset:0
    ds_read_b64_tr_b16 a[238:239], v11 offset:0
    v_mfma_f32_16x16x32_bf16 v[108:111], a[200:203], a[184:187], v[108:111]
    ds_read_b64_tr_b16 a[240:241], v10 offset:8192
    ds_read_b64_tr_b16 a[242:243], v11 offset:8192
    v_mfma_f32_16x16x32_bf16 v[116:119], a[200:203], a[188:191], v[116:119]
    ds_read_b64_tr_b16 a[244:245], v10 offset:16384
    ds_read_b64_tr_b16 a[246:247], v11 offset:16384
    v_mfma_f32_16x16x32_bf16 v[124:127], a[200:203], a[192:195], v[124:127]
    ds_read_b64_tr_b16 a[248:249], v10 offset:24576
    ds_read_b64_tr_b16 a[250:251], v11 offset:24576
    v_mfma_f32_16x16x32_bf16 v[132:135], a[200:203], a[196:199], v[132:135]
    ds_read_b64_tr_b16 a[252:253], v10 offset:32768
    ds_read_b64_tr_b16 a[254:255], v11 offset:32768
    v_rcp_f32 v45, v45
    v_rcp_f32 v46, v46
    v_pk_mul_f32 v[42:43], v[178:179], v[42:43]
    v_pk_mul_f32 v[44:45], v[184:185], v[44:45]
    v_pk_fma_f32 v[188:189], v[188:189], v[26:27], v[60:61]
    v_pk_fma_f32 v[190:191], v[190:191], v[26:27], v[62:63]
    v_cvt_pk_bf16_f32 v177, v42, v43
    v_mfma_f32_16x16x16_bf16 v[136:139], v[76:77], v[24:25], 0
    ds_write_b64 v28, v[176:177] offset:0
    v_mfma_f32_16x16x16_bf16 v[140:143], v[78:79], v[24:25], 0
    v_rcp_f32 v47, v47
    v_mfma_f32_16x16x16_bf16 v[144:147], v[80:81], v[24:25], 0
    v_exp_f32 v50, v194
    v_mfma_f32_16x16x16_bf16 v[148:151], v[82:83], v[24:25], 0
    v_cvt_pk_bf16_f32 v96, v96, v97
    v_cvt_pk_bf16_f32 v97, v98, v99
    v_mfma_f32_16x16x16_bf16 v[152:155], v[84:85], v[24:25], 0
    v_cvt_pk_bf16_f32 v98, v100, v101
    v_cvt_pk_bf16_f32 v99, v102, v103
    v_mfma_f32_16x16x16_bf16 v[156:159], v[86:87], v[24:25], 0
    v_cvt_pk_bf16_f32 v104, v104, v105
    v_cvt_pk_bf16_f32 v105, v106, v107
    v_mfma_f32_16x16x16_bf16 v[160:163], v[88:89], v[24:25], 0
    v_cvt_pk_bf16_f32 v106, v108, v109
    v_cvt_pk_bf16_f32 v107, v110, v111
    v_mfma_f32_16x16x16_bf16 v[164:167], v[90:91], v[24:25], 0
    v_cvt_pk_bf16_f32 v112, v112, v113
    v_cvt_pk_bf16_f32 v113, v114, v115
    v_mfma_f32_16x16x16_bf16 v[168:171], v[92:93], v[24:25], 0
    s_mov_b32 s50, 0
    buffer_store_dwordx4 v[96:99], v23, s[28:31], s50 offen offset:0 sc1 nt
    v_cvt_pk_bf16_f32 v114, v116, v117
    v_cvt_pk_bf16_f32 v115, v118, v119
    v_pk_mul_f32 v[46:47], v[186:187], v[46:47]
    v_pk_fma_f32 v[196:197], v[196:197], v[26:27], v[64:65]
    v_pk_fma_f32 v[198:199], v[198:199], v[26:27], v[66:67]
    v_cvt_pk_bf16_f32 v184, v44, v45
    v_mfma_f32_16x16x16_bf16 v[172:175], v[94:95], v[24:25], 0
    s_waitcnt lgkmcnt(15)
    v_cvt_pk_bf16_f32 v185, v46, v47
    v_exp_f32 v51, v195
    v_mfma_f32_16x16x32_bf16 v[136:139], a[204:207], a[0:3], v[136:139]
    v_rcp_f32 v48, v48
    v_cvt_pk_bf16_f32 v120, v120, v121
    v_mfma_f32_16x16x32_bf16 v[144:147], a[204:207], a[4:7], v[144:147]
    ds_read_b128 a[228:231], v14 offset:12800
    v_rcp_f32 v49, v49
    v_mfma_f32_16x16x32_bf16 v[152:155], a[204:207], a[8:11], v[152:155]
    v_exp_f32 v52, v200
    v_cvt_pk_bf16_f32 v121, v122, v123
    v_mfma_f32_16x16x32_bf16 v[160:163], a[204:207], a[12:15], v[160:163]
    v_exp_f32 v53, v201
    v_cvt_pk_bf16_f32 v122, v124, v125
    v_mfma_f32_16x16x32_bf16 v[168:171], a[204:207], a[16:19], v[168:171]
    v_exp_f32 v54, v202
    v_cvt_pk_bf16_f32 v123, v126, v127
    v_mfma_f32_16x16x32_bf16 v[140:143], a[208:211], a[0:3], v[140:143]
    v_exp_f32 v55, v203
    v_cvt_pk_bf16_f32 v128, v128, v129
    v_mfma_f32_16x16x32_bf16 v[148:151], a[208:211], a[4:7], v[148:151]
    ds_read_b128 a[232:235], v15 offset:12800
    v_exp_f32 v32, v208
    v_exp_f32 v33, v209
    v_pk_fma_f32 v[50:51], v[50:51], v[30:31], v[30:31]
    v_pk_mul_f32 v[48:49], v[192:193], v[48:49]
    v_pk_fma_f32 v[52:53], v[52:53], v[30:31], v[30:31]
    v_pk_fma_f32 v[54:55], v[54:55], v[30:31], v[30:31]
    v_pk_fma_f32 v[32:33], v[32:33], v[30:31], v[30:31]
    v_pk_fma_f32 v[204:205], v[204:205], v[26:27], v[68:69]
    v_pk_fma_f32 v[206:207], v[206:207], v[26:27], v[70:71]
    v_cvt_pk_bf16_f32 v192, v48, v49
    v_mfma_f32_16x16x32_bf16 v[156:159], a[208:211], a[8:11], v[156:159]
    v_rcp_f32 v50, v50
    v_cvt_pk_bf16_f32 v129, v130, v131
    v_mfma_f32_16x16x32_bf16 v[164:167], a[208:211], a[12:15], v[164:167]
    v_rcp_f32 v51, v51
    v_cvt_pk_bf16_f32 v130, v132, v133
    v_mfma_f32_16x16x32_bf16 v[172:175], a[208:211], a[16:19], v[172:175]
    s_waitcnt lgkmcnt(15)
    v_rcp_f32 v52, v52
    v_mfma_f32_16x16x32_bf16 v[136:139], a[212:215], a[20:23], v[136:139]
    ds_write_b64 v28, v[184:185] offset:8192
    v_cvt_pk_bf16_f32 v131, v134, v135
    v_mfma_f32_16x16x32_bf16 v[144:147], a[212:215], a[24:27], v[144:147]
    ds_read_b128 a[200:203], v14 offset:16896
    v_rcp_f32 v53, v53
    v_mfma_f32_16x16x32_bf16 v[152:155], a[212:215], a[28:31], v[152:155]
    s_mov_b32 s50, 524288
    buffer_store_dwordx4 v[104:107], v23, s[28:31], s50 offen offset:0 sc1 nt
    v_mfma_f32_16x16x32_bf16 v[160:163], a[212:215], a[32:35], v[160:163]
    v_rcp_f32 v54, v54
    v_mfma_f32_16x16x32_bf16 v[168:171], a[212:215], a[36:39], v[168:171]
    v_rcp_f32 v55, v55
    v_exp_f32 v34, v210
    v_exp_f32 v35, v211
    v_pk_mul_f32 v[50:51], v[194:195], v[50:51]
    v_pk_mul_f32 v[52:53], v[200:201], v[52:53]
    v_pk_mul_f32 v[54:55], v[202:203], v[54:55]
    v_pk_fma_f32 v[34:35], v[34:35], v[30:31], v[30:31]
    v_pk_fma_f32 v[212:213], v[212:213], v[26:27], v[72:73]
    v_pk_fma_f32 v[214:215], v[214:215], v[26:27], v[74:75]
    v_cvt_pk_bf16_f32 v193, v50, v51
    v_mfma_f32_16x16x32_bf16 v[140:143], a[216:219], a[20:23], v[140:143]
    v_rcp_f32 v32, v32
    v_mfma_f32_16x16x32_bf16 v[148:151], a[216:219], a[24:27], v[148:151]
    ds_read_b128 a[204:207], v15 offset:16896
    v_cvt_pk_bf16_f32 v200, v52, v53
    v_mfma_f32_16x16x32_bf16 v[156:159], a[216:219], a[28:31], v[156:159]
    v_rcp_f32 v33, v33
    v_mfma_f32_16x16x32_bf16 v[164:167], a[216:219], a[32:35], v[164:167]
    v_rcp_f32 v34, v34
    v_mfma_f32_16x16x32_bf16 v[172:175], a[216:219], a[36:39], v[172:175]
    s_waitcnt lgkmcnt(15)
    v_rcp_f32 v35, v35
    v_mfma_f32_16x16x32_bf16 v[136:139], a[220:223], a[40:43], v[136:139]
    v_exp_f32 v36, v180
    v_mfma_f32_16x16x32_bf16 v[144:147], a[220:223], a[44:47], v[144:147]
    ds_read_b128 a[208:211], v14 offset:20992
    v_cvt_pk_bf16_f32 v201, v54, v55
    v_mfma_f32_16x16x32_bf16 v[152:155], a[220:223], a[48:51], v[152:155]
    v_exp_f32 v37, v181
    v_exp_f32 v38, v182
    v_exp_f32 v39, v183
    v_pk_mul_f32 v[32:33], v[208:209], v[32:33]
    v_pk_mul_f32 v[34:35], v[210:211], v[34:35]
    v_pk_fma_f32 v[36:37], v[36:37], v[30:31], v[30:31]
    v_pk_fma_f32 v[38:39], v[38:39], v[30:31], v[30:31]
    v_pk_fma_f32 v[216:217], v[216:217], v[26:27], v[56:57]
    v_pk_fma_f32 v[218:219], v[218:219], v[26:27], v[58:59]
    v_cvt_pk_bf16_f32 v208, v32, v33
    v_mfma_f32_16x16x32_bf16 v[160:163], a[220:223], a[52:55], v[160:163]
    v_rcp_f32 v36, v36
    v_mfma_f32_16x16x32_bf16 v[168:171], a[220:223], a[56:59], v[168:171]
    ds_write_b64 v28, v[192:193] offset:16384
    v_mfma_f32_16x16x32_bf16 v[140:143], a[224:227], a[40:43], v[140:143]
    v_rcp_f32 v37, v37
    v_mfma_f32_16x16x32_bf16 v[148:151], a[224:227], a[44:47], v[148:151]
    s_mov_b32 s50, 1048576
    ds_write_b64 v28, v[200:201] offset:24576
    buffer_store_dwordx4 v[112:115], v23, s[28:31], s50 offen offset:0 sc1 nt
    v_mfma_f32_16x16x32_bf16 v[156:159], a[224:227], a[48:51], v[156:159]
    ds_read_b128 a[212:215], v15 offset:20992
    v_cvt_pk_bf16_f32 v209, v34, v35
    v_mfma_f32_16x16x32_bf16 v[164:167], a[224:227], a[52:55], v[164:167]
    v_rcp_f32 v38, v38
    v_mfma_f32_16x16x32_bf16 v[172:175], a[224:227], a[56:59], v[172:175]
    s_waitcnt lgkmcnt(8)
    v_rcp_f32 v39, v39
    v_mfma_f32_16x16x32_bf16 v[136:139], a[228:231], a[60:63], v[136:139]
    v_exp_f32 v40, v188
    v_exp_f32 v41, v189
    v_exp_f32 v42, v190
    v_pk_mul_f32 v[36:37], v[180:181], v[36:37]
    v_pk_mul_f32 v[38:39], v[182:183], v[38:39]
    v_pk_fma_f32 v[40:41], v[40:41], v[30:31], v[30:31]
    v_pk_fma_f32 v[224:225], v[224:225], v[26:27], v[60:61]
    v_pk_fma_f32 v[226:227], v[226:227], v[26:27], v[62:63]
    v_cvt_pk_bf16_f32 v180, v36, v37
    v_mfma_f32_16x16x32_bf16 v[144:147], a[228:231], a[64:67], v[144:147]
    ds_read_b128 a[216:219], v14 offset:25088
    v_cvt_pk_bf16_f32 v181, v38, v39
    v_mfma_f32_16x16x32_bf16 v[152:155], a[228:231], a[68:71], v[152:155]
    v_exp_f32 v43, v191
    v_mfma_f32_16x16x32_bf16 v[160:163], a[228:231], a[72:75], v[160:163]
    v_rcp_f32 v40, v40
    v_mfma_f32_16x16x32_bf16 v[168:171], a[228:231], a[76:79], v[168:171]
    s_waitcnt lgkmcnt(8)
    v_rcp_f32 v41, v41
    v_mfma_f32_16x16x32_bf16 v[140:143], a[232:235], a[60:63], v[140:143]
    v_exp_f32 v44, v196
    v_mfma_f32_16x16x32_bf16 v[148:151], a[232:235], a[64:67], v[148:151]
    ds_read_b128 a[220:223], v15 offset:25088
    v_exp_f32 v45, v197
    v_mfma_f32_16x16x32_bf16 v[156:159], a[232:235], a[68:71], v[156:159]
    v_exp_f32 v46, v198
    v_mfma_f32_16x16x32_bf16 v[164:167], a[232:235], a[72:75], v[164:167]
    ds_write_b64 v28, v[208:209] offset:32768
    v_exp_f32 v47, v199
    v_exp_f32 v48, v204
    v_pk_fma_f32 v[42:43], v[42:43], v[30:31], v[30:31]
    v_pk_mul_f32 v[40:41], v[188:189], v[40:41]
    v_pk_fma_f32 v[44:45], v[44:45], v[30:31], v[30:31]
    v_pk_fma_f32 v[46:47], v[46:47], v[30:31], v[30:31]
    v_pk_fma_f32 v[232:233], v[232:233], v[26:27], v[64:65]
    v_pk_fma_f32 v[234:235], v[234:235], v[26:27], v[66:67]
    v_cvt_pk_bf16_f32 v188, v40, v41
    v_mfma_f32_16x16x32_bf16 v[172:175], a[232:235], a[76:79], v[172:175]
    s_waitcnt lgkmcnt(8)
    v_rcp_f32 v42, v42
    v_mfma_f32_16x16x32_bf16 v[136:139], a[200:203], a[80:83], v[136:139]
    s_mov_b32 s50, 1572864
    ds_write_b64 v28, v[180:181] offset:256
    buffer_store_dwordx4 v[120:123], v23, s[28:31], s50 offen offset:0 sc1 nt
    v_mfma_f32_16x16x32_bf16 v[144:147], a[200:203], a[84:87], v[144:147]
    ds_read_b128 a[224:227], v14 offset:29184
    v_rcp_f32 v43, v43
    v_mfma_f32_16x16x32_bf16 v[152:155], a[200:203], a[88:91], v[152:155]
    v_rcp_f32 v44, v44
    v_mfma_f32_16x16x32_bf16 v[160:163], a[200:203], a[92:95], v[160:163]
    v_rcp_f32 v45, v45
    v_mfma_f32_16x16x32_bf16 v[168:171], a[200:203], a[96:99], v[168:171]
    s_waitcnt lgkmcnt(9)
    v_rcp_f32 v46, v46
    v_mfma_f32_16x16x32_bf16 v[140:143], a[204:207], a[80:83], v[140:143]
    v_rcp_f32 v47, v47
    v_mfma_f32_16x16x32_bf16 v[148:151], a[204:207], a[84:87], v[148:151]
    ds_read_b128 a[228:231], v15 offset:29184
    v_exp_f32 v49, v205
    v_exp_f32 v50, v206
    v_pk_mul_f32 v[42:43], v[190:191], v[42:43]
    v_pk_mul_f32 v[44:45], v[196:197], v[44:45]
    v_pk_mul_f32 v[46:47], v[198:199], v[46:47]
    v_pk_fma_f32 v[48:49], v[48:49], v[30:31], v[30:31]
    v_pk_fma_f32 v[240:241], v[240:241], v[26:27], v[68:69]
    v_pk_fma_f32 v[242:243], v[242:243], v[26:27], v[70:71]
    v_cvt_pk_bf16_f32 v189, v42, v43
    v_mfma_f32_16x16x32_bf16 v[156:159], a[204:207], a[88:91], v[156:159]
    v_exp_f32 v51, v207
    v_mfma_f32_16x16x32_bf16 v[164:167], a[204:207], a[92:95], v[164:167]
    v_rcp_f32 v48, v48
    v_mfma_f32_16x16x32_bf16 v[172:175], a[204:207], a[96:99], v[172:175]
    s_waitcnt lgkmcnt(9)
    v_rcp_f32 v49, v49
    v_mfma_f32_16x16x32_bf16 v[136:139], a[208:211], a[100:103], v[136:139]
    v_exp_f32 v52, v212
    v_mfma_f32_16x16x32_bf16 v[144:147], a[208:211], a[104:107], v[144:147]
    ds_read_b128 a[232:235], v14 offset:33280
    v_cvt_pk_bf16_f32 v196, v44, v45
    v_mfma_f32_16x16x32_bf16 v[152:155], a[208:211], a[108:111], v[152:155]
    ds_write_b64 v28, v[188:189] offset:8448
    v_mfma_f32_16x16x32_bf16 v[160:163], a[208:211], a[112:115], v[160:163]
    v_exp_f32 v53, v213
    v_mfma_f32_16x16x32_bf16 v[168:171], a[208:211], a[116:119], v[168:171]
    s_waitcnt lgkmcnt(8)
    s_mov_b32 s50, 2097152
    buffer_store_dwordx4 v[128:131], v23, s[28:31], s50 offen offset:0 sc1 nt
    v_exp_f32 v54, v214
    v_pk_fma_f32 v[50:51], v[50:51], v[30:31], v[30:31]
    v_pk_mul_f32 v[48:49], v[204:205], v[48:49]
    v_pk_fma_f32 v[52:53], v[52:53], v[30:31], v[30:31]
    v_cvt_pk_bf16_f32 v197, v46, v47
    v_mfma_f32_16x16x32_bf16 v[140:143], a[212:215], a[100:103], v[140:143]
    v_rcp_f32 v50, v50
    v_mfma_f32_16x16x32_bf16 v[148:151], a[212:215], a[104:107], v[148:151]
    ds_read_b128 a[200:203], v15 offset:33280
    v_cvt_pk_bf16_f32 v204, v48, v49
    v_mfma_f32_16x16x32_bf16 v[156:159], a[212:215], a[108:111], v[156:159]
    v_rcp_f32 v51, v51
    v_mfma_f32_16x16x32_bf16 v[164:167], a[212:215], a[112:115], v[164:167]
    v_exp_f32 v55, v215
    v_mfma_f32_16x16x32_bf16 v[172:175], a[212:215], a[116:119], v[172:175]
    s_waitcnt lgkmcnt(8)
    v_rcp_f32 v52, v52
    v_mfma_f32_16x16x32_bf16 v[136:139], a[216:219], a[120:123], v[136:139]
    v_rcp_f32 v53, v53
    v_mfma_f32_16x16x32_bf16 v[144:147], a[216:219], a[124:127], v[144:147]
    ds_read_b128 a[204:207], v14 offset:37376
    v_exp_f32 v32, v216
    v_mfma_f32_16x16x32_bf16 v[152:155], a[216:219], a[128:131], v[152:155]
    v_exp_f32 v33, v217
    v_exp_f32 v34, v218
    v_exp_f32 v35, v219
    v_pk_mul_f32 v[50:51], v[206:207], v[50:51]
    v_pk_fma_f32 v[54:55], v[54:55], v[30:31], v[30:31]
    v_pk_mul_f32 v[52:53], v[212:213], v[52:53]
    v_pk_fma_f32 v[32:33], v[32:33], v[30:31], v[30:31]
    v_pk_fma_f32 v[34:35], v[34:35], v[30:31], v[30:31]
    v_pk_fma_f32 v[248:249], v[248:249], v[26:27], v[72:73]
    v_pk_fma_f32 v[250:251], v[250:251], v[26:27], v[74:75]
    v_cvt_pk_bf16_f32 v205, v50, v51
    v_mfma_f32_16x16x32_bf16 v[160:163], a[216:219], a[132:135], v[160:163]
    v_rcp_f32 v54, v54
    v_mfma_f32_16x16x32_bf16 v[168:171], a[216:219], a[136:139], v[168:171]
    s_waitcnt lgkmcnt(8)
    v_rcp_f32 v55, v55
    v_mfma_f32_16x16x32_bf16 v[140:143], a[220:223], a[120:123], v[140:143]
    v_rcp_f32 v32, v32
    v_mfma_f32_16x16x32_bf16 v[148:151], a[220:223], a[124:127], v[148:151]
    ds_write_b64 v28, v[196:197] offset:16640
    ds_read_b128 a[208:211], v15 offset:37376
    v_mfma_f32_16x16x32_bf16 v[156:159], a[220:223], a[128:131], v[156:159]
    v_rcp_f32 v33, v33
    v_mfma_f32_16x16x32_bf16 v[164:167], a[220:223], a[132:135], v[164:167]
    ds_write_b64 v28, v[204:205] offset:24832
    v_mfma_f32_16x16x32_bf16 v[172:175], a[220:223], a[136:139], v[172:175]
    s_waitcnt lgkmcnt(8)
    v_rcp_f32 v34, v34
    v_mfma_f32_16x16x32_bf16 v[136:139], a[224:227], a[140:143], v[136:139]
    v_cvt_pk_bf16_f32 v212, v52, v53
    v_rcp_f32 v35, v35
    v_exp_f32 v36, v224
    v_pk_mul_f32 v[54:55], v[214:215], v[54:55]
    v_pk_mul_f32 v[32:33], v[216:217], v[32:33]
    v_pk_mul_f32 v[34:35], v[218:219], v[34:35]
    v_pk_fma_f32 v[220:221], v[220:221], v[26:27], v[56:57]
    v_pk_fma_f32 v[222:223], v[222:223], v[26:27], v[58:59]
    v_cvt_pk_bf16_f32 v213, v54, v55
    v_mfma_f32_16x16x32_bf16 v[144:147], a[224:227], a[144:147], v[144:147]
    v_exp_f32 v37, v225
    v_mfma_f32_16x16x32_bf16 v[152:155], a[224:227], a[148:151], v[152:155]
    ds_write_b64 v28, v[212:213] offset:33024
    v_mfma_f32_16x16x32_bf16 v[160:163], a[224:227], a[152:155], v[160:163]
    v_exp_f32 v38, v226
    v_mfma_f32_16x16x32_bf16 v[168:171], a[224:227], a[156:159], v[168:171]
    s_waitcnt lgkmcnt(8)
    v_exp_f32 v39, v227
    v_mfma_f32_16x16x32_bf16 v[140:143], a[228:231], a[140:143], v[140:143]
    v_exp_f32 v40, v232
    v_mfma_f32_16x16x32_bf16 v[148:151], a[228:231], a[144:147], v[148:151]
    v_exp_f32 v41, v233
    v_mfma_f32_16x16x32_bf16 v[156:159], a[228:231], a[148:151], v[156:159]
    v_exp_f32 v42, v234
    v_mfma_f32_16x16x32_bf16 v[164:167], a[228:231], a[152:155], v[164:167]
    v_cvt_pk_bf16_f32 v216, v32, v33
    v_cvt_pk_bf16_f32 v217, v34, v35
    v_exp_f32 v43, v235
    v_exp_f32 v44, v240
    v_pk_fma_f32 v[36:37], v[36:37], v[30:31], v[30:31]
    v_pk_fma_f32 v[38:39], v[38:39], v[30:31], v[30:31]
    v_pk_fma_f32 v[40:41], v[40:41], v[30:31], v[30:31]
    v_pk_fma_f32 v[42:43], v[42:43], v[30:31], v[30:31]
    v_fma_f32 v228, v228, v26, v60
    v_mfma_f32_16x16x32_bf16 v[172:175], a[228:231], a[156:159], v[172:175]
    s_waitcnt lgkmcnt(7)
    v_rcp_f32 v36, v36
    v_mfma_f32_16x16x32_bf16 v[136:139], a[232:235], a[160:163], v[136:139]
    ds_write_b64 v28, v[216:217] offset:512
    v_mfma_f32_16x16x32_bf16 v[144:147], a[232:235], a[164:167], v[144:147]
    v_rcp_f32 v37, v37
    v_mfma_f32_16x16x32_bf16 v[152:155], a[232:235], a[168:171], v[152:155]
    v_rcp_f32 v38, v38
    v_mfma_f32_16x16x32_bf16 v[160:163], a[232:235], a[172:175], v[160:163]
    v_rcp_f32 v39, v39
    v_mfma_f32_16x16x32_bf16 v[168:171], a[232:235], a[176:179], v[168:171]
    s_waitcnt lgkmcnt(6)
    v_rcp_f32 v40, v40
    v_mfma_f32_16x16x32_bf16 v[140:143], a[200:203], a[160:163], v[140:143]
    v_rcp_f32 v41, v41
    v_mfma_f32_16x16x32_bf16 v[148:151], a[200:203], a[164:167], v[148:151]
    v_rcp_f32 v42, v42
    v_rcp_f32 v43, v43
    v_fma_f32 v229, v229, v26, v61
    v_pk_mul_f32 v[36:37], v[224:225], v[36:37]
    v_pk_mul_f32 v[38:39], v[226:227], v[38:39]
    v_pk_mul_f32 v[40:41], v[232:233], v[40:41]
    v_pk_mul_f32 v[42:43], v[234:235], v[42:43]
    v_cvt_pk_bf16_f32 v224, v36, v37
    v_mfma_f32_16x16x32_bf16 v[156:159], a[200:203], a[168:171], v[156:159]
    v_cvt_pk_bf16_f32 v225, v38, v39
    v_cvt_pk_bf16_f32 v232, v40, v41
    v_mfma_f32_16x16x32_bf16 v[164:167], a[200:203], a[172:175], v[164:167]
    ds_write_b64 v28, v[224:225] offset:8704
    v_mfma_f32_16x16x32_bf16 v[172:175], a[200:203], a[176:179], v[172:175]
    s_waitcnt lgkmcnt(6)
    v_cvt_pk_bf16_f32 v233, v42, v43
    v_fma_f32 v230, v230, v26, v62
    v_mfma_f32_16x16x32_bf16 v[136:139], a[204:207], a[180:183], v[136:139]
    s_waitcnt lgkmcnt(2)
    ds_write_b64 v28, v[232:233] offset:16896
    v_mfma_f32_16x16x32_bf16 v[144:147], a[204:207], a[184:187], v[144:147]
    s_barrier
    v_mfma_f32_16x16x32_bf16 v[152:155], a[204:207], a[188:191], v[152:155]
    ds_read_b128 a[212:215], v6 offset:0
    ds_read_b128 a[216:219], v7 offset:0
    v_mfma_f32_16x16x32_bf16 v[160:163], a[204:207], a[192:195], v[160:163]
    ds_read_b128 a[220:223], v6 offset:4096
    ds_read_b128 a[224:227], v7 offset:4096
    v_mfma_f32_16x16x32_bf16 v[168:171], a[204:207], a[196:199], v[168:171]
    ds_read_b128 a[228:231], v6 offset:8192
    ds_read_b128 a[232:235], v7 offset:8192
    v_mfma_f32_16x16x32_bf16 v[140:143], a[208:211], a[180:183], v[140:143]
    ds_read_b64_tr_b16 v[76:77], v12 offset:0
    ds_read_b64_tr_b16 v[78:79], v13 offset:0
    v_mfma_f32_16x16x32_bf16 v[148:151], a[208:211], a[184:187], v[148:151]
    ds_read_b64_tr_b16 v[80:81], v12 offset:8192
    ds_read_b64_tr_b16 v[82:83], v13 offset:8192
    v_mfma_f32_16x16x32_bf16 v[156:159], a[208:211], a[188:191], v[156:159]
    ds_read_b64_tr_b16 v[84:85], v12 offset:16384
    ds_read_b64_tr_b16 v[86:87], v13 offset:16384
    v_mfma_f32_16x16x32_bf16 v[164:167], a[208:211], a[192:195], v[164:167]
    ds_read_b64_tr_b16 v[88:89], v12 offset:24576
    ds_read_b64_tr_b16 v[90:91], v13 offset:24576
    v_mfma_f32_16x16x32_bf16 v[172:175], a[208:211], a[196:199], v[172:175]
    ds_read_b64_tr_b16 v[92:93], v12 offset:32768
    ds_read_b64_tr_b16 v[94:95], v13 offset:32768
    v_mfma_f32_16x16x16_bf16 v[176:179], a[236:237], v[24:25], 0
    v_exp_f32 v45, v241
    v_mfma_f32_16x16x16_bf16 v[180:183], a[238:239], v[24:25], 0
    v_exp_f32 v46, v242
    v_mfma_f32_16x16x16_bf16 v[184:187], a[240:241], v[24:25], 0
    v_exp_f32 v47, v243
    v_exp_f32 v48, v248
    v_fma_f32 v231, v231, v26, v63
    v_pk_fma_f32 v[44:45], v[44:45], v[30:31], v[30:31]
    v_pk_fma_f32 v[46:47], v[46:47], v[30:31], v[30:31]
    v_fma_f32 v236, v236, v26, v64
    v_mfma_f32_16x16x16_bf16 v[188:191], a[242:243], v[24:25], 0
    v_cvt_pk_bf16_f32 v136, v136, v137
    v_cvt_pk_bf16_f32 v137, v138, v139
    v_mfma_f32_16x16x16_bf16 v[192:195], a[244:245], v[24:25], 0
    v_cvt_pk_bf16_f32 v138, v140, v141
    v_cvt_pk_bf16_f32 v139, v142, v143
    v_mfma_f32_16x16x16_bf16 v[196:199], a[246:247], v[24:25], 0
    v_cvt_pk_bf16_f32 v144, v144, v145
    v_cvt_pk_bf16_f32 v145, v146, v147
    v_mfma_f32_16x16x16_bf16 v[200:203], a[248:249], v[24:25], 0
    v_cvt_pk_bf16_f32 v146, v148, v149
    v_cvt_pk_bf16_f32 v147, v150, v151
    v_mfma_f32_16x16x16_bf16 v[204:207], a[250:251], v[24:25], 0
    v_cvt_pk_bf16_f32 v152, v152, v153
    v_cvt_pk_bf16_f32 v153, v154, v155
    v_mfma_f32_16x16x16_bf16 v[208:211], a[252:253], v[24:25], 0
    s_mov_b32 s50, 0
    buffer_store_dwordx4 v[136:139], v23, s[28:31], s50 offen offset:64 sc1 nt
    v_mfma_f32_16x16x16_bf16 v[212:215], a[254:255], v[24:25], 0
    s_waitcnt lgkmcnt(15)
    v_cvt_pk_bf16_f32 v154, v156, v157
    v_cvt_pk_bf16_f32 v155, v158, v159
    v_mfma_f32_16x16x32_bf16 v[176:179], a[212:215], a[0:3], v[176:179]
    v_rcp_f32 v44, v44
    v_mfma_f32_16x16x32_bf16 v[184:187], a[212:215], a[4:7], v[184:187]
    s_waitcnt lgkmcnt(14)
    ds_read_b128 a[200:203], v6 offset:12288
    v_cvt_pk_bf16_f32 v160, v160, v161
    v_mfma_f32_16x16x32_bf16 v[180:183], a[216:219], a[0:3], v[180:183]
    v_rcp_f32 v45, v45
    v_mfma_f32_16x16x32_bf16 v[188:191], a[216:219], a[4:7], v[188:191]
    s_waitcnt lgkmcnt(14)
    ds_read_b128 a[204:207], v7 offset:12288
    v_cvt_pk_bf16_f32 v161, v162, v163
    v_mfma_f32_16x16x32_bf16 v[176:179], a[220:223], a[20:23], v[176:179]
    v_rcp_f32 v46, v46
    v_mfma_f32_16x16x32_bf16 v[184:187], a[220:223], a[24:27], v[184:187]
    s_waitcnt lgkmcnt(14)
    ds_read_b128 a[208:211], v6 offset:16384
    v_cvt_pk_bf16_f32 v162, v164, v165
    v_mfma_f32_16x16x32_bf16 v[180:183], a[224:227], a[20:23], v[180:183]
    v_rcp_f32 v47, v47
    v_mfma_f32_16x16x32_bf16 v[188:191], a[224:227], a[24:27], v[188:191]
    s_waitcnt lgkmcnt(14)
    ds_read_b128 a[212:215], v7 offset:16384
    v_exp_f32 v49, v249
    v_exp_f32 v50, v250
    v_pk_mul_f32 v[44:45], v[240:241], v[44:45]
    v_pk_mul_f32 v[46:47], v[242:243], v[46:47]
    v_pk_fma_f32 v[48:49], v[48:49], v[30:31], v[30:31]
    v_cvt_pk_bf16_f32 v240, v44, v45
    v_mfma_f32_16x16x32_bf16 v[176:179], a[228:231], a[40:43], v[176:179]
    v_cvt_pk_bf16_f32 v241, v46, v47
    v_cvt_pk_bf16_f32 v163, v166, v167
    v_mfma_f32_16x16x32_bf16 v[184:187], a[228:231], a[44:47], v[184:187]
    s_waitcnt lgkmcnt(14)
    ds_read_b128 a[216:219], v6 offset:20480
    v_cvt_pk_bf16_f32 v168, v168, v169
    v_mfma_f32_16x16x32_bf16 v[180:183], a[232:235], a[40:43], v[180:183]
    ds_write_b64 v28, v[240:241] offset:25088
    v_mfma_f32_16x16x32_bf16 v[188:191], a[232:235], a[44:47], v[188:191]
    s_waitcnt lgkmcnt(5)
    ds_read_b128 a[220:223], v7 offset:20480
    v_cvt_pk_bf16_f32 v169, v170, v171
    v_mfma_f32_16x16x32_bf16 v[176:179], a[200:203], a[60:63], v[176:179]
    s_mov_b32 s50, 524288
    buffer_store_dwordx4 v[144:147], v23, s[28:31], s50 offen offset:64 sc1 nt
    v_mfma_f32_16x16x32_bf16 v[184:187], a[200:203], a[64:67], v[184:187]
    s_waitcnt lgkmcnt(5)
    ds_read_b128 a[224:227], v6 offset:24576
    v_cvt_pk_bf16_f32 v170, v172, v173
    v_mfma_f32_16x16x32_bf16 v[180:183], a[204:207], a[60:63], v[180:183]
    v_exp_f32 v51, v251
    v_mfma_f32_16x16x32_bf16 v[188:191], a[204:207], a[64:67], v[188:191]
    s_waitcnt lgkmcnt(5)
    ds_read_b128 a[228:231], v7 offset:24576
    v_cvt_pk_bf16_f32 v171, v174, v175
    v_mfma_f32_16x16x32_bf16 v[176:179], a[208:211], a[80:83], v[176:179]
    v_rcp_f32 v48, v48
    v_fma_f32 v237, v237, v26, v65
    v_mfma_f32_16x16x32_bf16 v[184:187], a[208:211], a[84:87], v[184:187]
    s_waitcnt lgkmcnt(5)
    ds_read_b128 a[232:235], v6 offset:28672
    v_rcp_f32 v49, v49
    v_mfma_f32_16x16x32_bf16 v[180:183], a[212:215], a[80:83], v[180:183]
    v_exp_f32 v52, v220
    v_exp_f32 v53, v221
    v_fma_f32 v238, v238, v26, v66
    v_pk_fma_f32 v[50:51], v[50:51], v[30:31], v[30:31]
    v_pk_mul_f32 v[48:49], v[248:249], v[48:49]
    v_pk_fma_f32 v[52:53], v[52:53], v[30:31], v[30:31]
    v_cvt_pk_bf16_f32 v248, v48, v49
    v_mfma_f32_16x16x32_bf16 v[188:191], a[212:215], a[84:87], v[188:191]
    s_waitcnt lgkmcnt(5)
    ds_read_b128 a[200:203], v7 offset:28672
    v_rcp_f32 v50, v50
    v_mfma_f32_16x16x32_bf16 v[176:179], a[216:219], a[100:103], v[176:179]
    v_rcp_f32 v51, v51
    v_fma_f32 v239, v239, v26, v67
    v_mfma_f32_16x16x32_bf16 v[184:187], a[216:219], a[104:107], v[184:187]
    s_waitcnt lgkmcnt(4)
    ds_read_b128 a[204:207], v6 offset:32768
    v_exp_f32 v54, v222
    v_mfma_f32_16x16x32_bf16 v[180:183], a[220:223], a[100:103], v[180:183]
    v_exp_f32 v55, v223
    v_fma_f32 v244, v244, v26, v68
    v_mfma_f32_16x16x32_bf16 v[188:191], a[220:223], a[104:107], v[188:191]
    s_waitcnt lgkmcnt(4)
    ds_read_b128 a[208:211], v7 offset:32768
    v_rcp_f32 v52, v52
    v_mfma_f32_16x16x32_bf16 v[176:179], a[224:227], a[120:123], v[176:179]
    v_rcp_f32 v53, v53
    v_fma_f32 v245, v245, v26, v69
    v_mfma_f32_16x16x32_bf16 v[184:187], a[224:227], a[124:127], v[184:187]
    s_waitcnt lgkmcnt(4)
    ds_read_b128 a[212:215], v6 offset:36864
    v_exp_f32 v32, v228
    v_mfma_f32_16x16x32_bf16 v[180:183], a[228:231], a[120:123], v[180:183]
    s_mov_b32 s50, 1048576
    buffer_store_dwordx4 v[152:155], v23, s[28:31], s50 offen offset:64 sc1 nt
    v_exp_f32 v33, v229
    v_fma_f32 v32, v32, v30, v30
    v_pk_mul_f32 v[50:51], v[250:251], v[50:51]
    v_pk_fma_f32 v[54:55], v[54:55], v[30:31], v[30:31]
    v_pk_mul_f32 v[52:53], v[220:221], v[52:53]
    v_cvt_pk_bf16_f32 v249, v50, v51
    v_mfma_f32_16x16x32_bf16 v[188:191], a[228:231], a[124:127], v[188:191]
    s_waitcnt lgkmcnt(4)
    ds_read_b128 a[216:219], v7 offset:36864
    v_rcp_f32 v54, v54
    v_mfma_f32_16x16x32_bf16 v[176:179], a[232:235], a[140:143], v[176:179]
    v_rcp_f32 v55, v55
    v_cvt_pk_bf16_f32 v220, v52, v53
    v_mfma_f32_16x16x32_bf16 v[184:187], a[232:235], a[144:147], v[184:187]
    s_waitcnt lgkmcnt(4)
    ds_read_b128 a[220:223], v6 offset:0
    v_exp_f32 v34, v230
    v_mfma_f32_16x16x32_bf16 v[180:183], a[200:203], a[140:143], v[180:183]
    v_exp_f32 v35, v231
    v_fma_f32 v33, v33, v30, v30
    v_mfma_f32_16x16x32_bf16 v[188:191], a[200:203], a[144:147], v[188:191]
    s_waitcnt lgkmcnt(4)
    ds_read_b128 a[224:227], v7 offset:0
    v_fma_f32 v34, v34, v30, v30
    v_fma_f32 v35, v35, v30, v30
    v_mfma_f32_16x16x32_bf16 v[176:179], a[204:207], a[160:163], v[176:179]
    v_rcp_f32 v32, v32
    v_fma_f32 v246, v246, v26, v70
    v_mfma_f32_16x16x32_bf16 v[184:187], a[204:207], a[164:167], v[184:187]
    s_waitcnt lgkmcnt(4)
    ds_read_b128 a[228:231], v6 offset:4096
    v_rcp_f32 v33, v33
    v_mfma_f32_16x16x32_bf16 v[180:183], a[208:211], a[160:163], v[180:183]
    v_rcp_f32 v34, v34
    v_mul_f32 v32, v228, v32
    v_mfma_f32_16x16x32_bf16 v[188:191], a[208:211], a[164:167], v[188:191]
    s_waitcnt lgkmcnt(4)
    ds_read_b128 a[232:235], v7 offset:4096
    v_rcp_f32 v35, v35
    v_mfma_f32_16x16x32_bf16 v[176:179], a[212:215], a[180:183], v[176:179]
    v_mul_f32 v33, v229, v33
    v_mul_f32 v34, v230, v34
    v_mul_f32 v35, v231, v35
    v_mfma_f32_16x16x32_bf16 v[184:187], a[212:215], a[184:187], v[184:187]
    s_waitcnt lgkmcnt(4)
    ds_read_b128 a[200:203], v6 offset:8192
    v_cvt_pk_bf16_f32 v228, v32, v33
    v_cvt_pk_bf16_f32 v229, v34, v35
    v_mfma_f32_16x16x32_bf16 v[180:183], a[216:219], a[180:183], v[180:183]
    ds_write_b64 v28, v[248:249] offset:33280
    v_fma_f32 v247, v247, v26, v71
    v_mfma_f32_16x16x32_bf16 v[188:191], a[216:219], a[184:187], v[188:191]
    s_waitcnt lgkmcnt(5)
    ds_read_b128 a[204:207], v7 offset:8192
    v_exp_f32 v36, v236
    v_mfma_f32_16x16x32_bf16 v[192:195], a[220:223], a[8:11], v[192:195]
    s_mov_b32 s50, 1572864
    ds_write_b64 v28, v[228:229] offset:8960
    buffer_store_dwordx4 v[160:163], v23, s[28:31], s50 offen offset:64 sc1 nt
    v_fma_f32 v36, v36, v30, v30
    v_mfma_f32_16x16x32_bf16 v[200:203], a[220:223], a[12:15], v[200:203]
    ds_read_b128 a[208:211], v6 offset:12288
    v_exp_f32 v37, v237
    v_mfma_f32_16x16x32_bf16 v[208:211], a[220:223], a[16:19], v[208:211]
    s_waitcnt lgkmcnt(7)
    v_exp_f32 v38, v238
    v_exp_f32 v39, v239
    v_fma_f32 v37, v37, v30, v30
    v_pk_mul_f32 v[54:55], v[222:223], v[54:55]
    v_fma_f32 v38, v38, v30, v30
    v_mfma_f32_16x16x32_bf16 v[196:199], a[224:227], a[8:11], v[196:199]
    v_cvt_pk_bf16_f32 v176, v176, v177
    v_cvt_pk_bf16_f32 v177, v178, v179
    v_cvt_pk_bf16_f32 v178, v180, v181
    v_mfma_f32_16x16x32_bf16 v[204:207], a[224:227], a[12:15], v[204:207]
    ds_read_b128 a[212:215], v7 offset:12288
    v_cvt_pk_bf16_f32 v179, v182, v183
    v_cvt_pk_bf16_f32 v221, v54, v55
    v_mfma_f32_16x16x32_bf16 v[212:215], a[224:227], a[16:19], v[212:215]
    s_waitcnt lgkmcnt(7)
    v_fma_f32 v39, v39, v30, v30
    v_rcp_f32 v36, v36
    v_mfma_f32_16x16x32_bf16 v[192:195], a[228:231], a[28:31], v[192:195]
    v_rcp_f32 v37, v37
    v_mul_f32 v36, v236, v36
    v_mfma_f32_16x16x32_bf16 v[200:203], a[228:231], a[32:35], v[200:203]
    ds_read_b128 a[216:219], v6 offset:16384
    v_rcp_f32 v38, v38
    v_mfma_f32_16x16x32_bf16 v[208:211], a[228:231], a[36:39], v[208:211]
    s_waitcnt lgkmcnt(7)
    v_rcp_f32 v39, v39
    v_mfma_f32_16x16x32_bf16 v[196:199], a[232:235], a[28:31], v[196:199]
    v_mul_f32 v37, v237, v37
    v_mul_f32 v38, v238, v38
    v_mfma_f32_16x16x32_bf16 v[204:207], a[232:235], a[32:35], v[204:207]
    ds_read_b128 a[220:223], v7 offset:16384
    v_mul_f32 v39, v239, v39
    v_mfma_f32_16x16x32_bf16 v[212:215], a[232:235], a[36:39], v[212:215]
    s_waitcnt lgkmcnt(7)
    v_cvt_pk_bf16_f32 v236, v36, v37
    v_cvt_pk_bf16_f32 v237, v38, v39
    v_mfma_f32_16x16x32_bf16 v[192:195], a[200:203], a[48:51], v[192:195]
    ds_write_b64 v28, v[220:221] offset:768
    v_cvt_pk_bf16_f32 v184, v184, v185
    v_mfma_f32_16x16x32_bf16 v[200:203], a[200:203], a[52:55], v[200:203]
    ds_read_b128 a[224:227], v6 offset:20480
    v_cvt_pk_bf16_f32 v185, v186, v187
    v_cvt_pk_bf16_f32 v186, v188, v189
    v_mfma_f32_16x16x32_bf16 v[208:211], a[200:203], a[56:59], v[208:211]
    s_waitcnt lgkmcnt(7)
    s_mov_b32 s50, 2097152
    ds_write_b64 v28, v[236:237] offset:17152
    buffer_store_dwordx4 v[168:171], v23, s[28:31], s50 offen offset:64 sc1 nt
    v_cvt_pk_bf16_f32 v187, v190, v191
    v_mfma_f32_16x16x32_bf16 v[196:199], a[204:207], a[48:51], v[196:199]
    v_exp_f32 v40, v244
    v_fma_f32 v252, v252, v26, v72
    v_mfma_f32_16x16x32_bf16 v[204:207], a[204:207], a[52:55], v[204:207]
    ds_read_b128 a[228:231], v7 offset:20480
    v_fma_f32 v40, v40, v30, v30
    v_mfma_f32_16x16x32_bf16 v[212:215], a[204:207], a[56:59], v[212:215]
    s_waitcnt lgkmcnt(7)
    v_exp_f32 v41, v245
    v_mfma_f32_16x16x32_bf16 v[192:195], a[208:211], a[68:71], v[192:195]
    v_exp_f32 v42, v246
    v_mfma_f32_16x16x32_bf16 v[200:203], a[208:211], a[72:75], v[200:203]
    ds_read_b128 a[232:235], v6 offset:24576
    v_fma_f32 v41, v41, v30, v30
    v_mfma_f32_16x16x32_bf16 v[208:211], a[208:211], a[76:79], v[208:211]
    s_waitcnt lgkmcnt(7)
    v_exp_f32 v43, v247
    v_mfma_f32_16x16x32_bf16 v[196:199], a[212:215], a[68:71], v[196:199]
    v_fma_f32 v42, v42, v30, v30
    v_fma_f32 v43, v43, v30, v30
    v_mfma_f32_16x16x32_bf16 v[204:207], a[212:215], a[72:75], v[204:207]
    ds_read_b128 a[200:203], v7 offset:24576
    v_fma_f32 v253, v253, v26, v73
    v_mfma_f32_16x16x32_bf16 v[212:215], a[212:215], a[76:79], v[212:215]
    s_waitcnt lgkmcnt(7)
    v_rcp_f32 v40, v40
    v_mfma_f32_16x16x32_bf16 v[192:195], a[216:219], a[88:91], v[192:195]
    v_rcp_f32 v41, v41
    v_mfma_f32_16x16x32_bf16 v[200:203], a[216:219], a[92:95], v[200:203]
    ds_read_b128 a[204:207], v6 offset:28672
    v_mul_f32 v40, v244, v40
    v_mfma_f32_16x16x32_bf16 v[208:211], a[216:219], a[96:99], v[208:211]
    s_waitcnt lgkmcnt(7)
    v_rcp_f32 v42, v42
    v_mfma_f32_16x16x32_bf16 v[196:199], a[220:223], a[88:91], v[196:199]
    v_rcp_f32 v43, v43
    v_mfma_f32_16x16x32_bf16 v[204:207], a[220:223], a[92:95], v[204:207]
    s_mov_b32 s50, 0
    buffer_store_dwordx4 v[176:179], v23, s[28:31], s50 offen offset:128 sc1 nt
    v_mul_f32 v41, v245, v41
    v_mfma_f32_16x16x32_bf16 v[212:215], a[220:223], a[96:99], v[212:215]
    s_waitcnt lgkmcnt(5)
    ds_read_b128 a[208:211], v7 offset:28672
    v_mul_f32 v42, v246, v42
    v_mul_f32 v43, v247, v43
    v_mfma_f32_16x16x32_bf16 v[192:195], a[224:227], a[108:111], v[192:195]
    v_cvt_pk_bf16_f32 v244, v40, v41
    v_cvt_pk_bf16_f32 v245, v42, v43
    v_mfma_f32_16x16x32_bf16 v[200:203], a[224:227], a[112:115], v[200:203]
    ds_read_b128 a[212:215], v6 offset:32768
    v_fma_f32 v254, v254, v26, v74
    v_mfma_f32_16x16x32_bf16 v[208:211], a[224:227], a[116:119], v[208:211]
    s_waitcnt lgkmcnt(5)
    v_exp_f32 v44, v252
    v_mfma_f32_16x16x32_bf16 v[196:199], a[228:231], a[108:111], v[196:199]
    v_exp_f32 v45, v253
    v_mfma_f32_16x16x32_bf16 v[204:207], a[228:231], a[112:115], v[204:207]
    ds_read_b128 a[216:219], v7 offset:32768
    v_fma_f32 v255, v255, v26, v75
    v_mfma_f32_16x16x32_bf16 v[212:215], a[228:231], a[116:119], v[212:215]
    s_waitcnt lgkmcnt(5)
    v_exp_f32 v46, v254
    v_mfma_f32_16x16x32_bf16 v[192:195], a[232:235], a[128:131], v[192:195]
    v_exp_f32 v47, v255
    v_mfma_f32_16x16x32_bf16 v[200:203], a[232:235], a[132:135], v[200:203]
    ds_read_b128 a[220:223], v6 offset:36864
    v_fma_f32 v44, v44, v30, v30
    v_mfma_f32_16x16x32_bf16 v[208:211], a[232:235], a[136:139], v[208:211]
    s_waitcnt lgkmcnt(5)
    v_fma_f32 v45, v45, v30, v30
    v_fma_f32 v46, v46, v30, v30
    v_mfma_f32_16x16x32_bf16 v[196:199], a[200:203], a[128:131], v[196:199]
    v_rcp_f32 v44, v44
    v_mfma_f32_16x16x32_bf16 v[204:207], a[200:203], a[132:135], v[204:207]
    ds_write_b64 v28, v[244:245] offset:25344
    ds_read_b128 a[224:227], v7 offset:36864
    v_fma_f32 v47, v47, v30, v30
    v_mfma_f32_16x16x32_bf16 v[212:215], a[200:203], a[136:139], v[212:215]
    s_waitcnt lgkmcnt(6)
    v_rcp_f32 v45, v45
    v_mfma_f32_16x16x32_bf16 v[192:195], a[204:207], a[148:151], v[192:195]
    s_mov_b32 s50, 524288
    buffer_store_dwordx4 v[184:187], v23, s[28:31], s50 offen offset:128 sc1 nt
    v_mul_f32 v44, v252, v44
    v_mfma_f32_16x16x32_bf16 v[200:203], a[204:207], a[152:155], v[200:203]
    v_rcp_f32 v46, v46
    v_mul_f32 v45, v253, v45
    v_mfma_f32_16x16x32_bf16 v[208:211], a[204:207], a[156:159], v[208:211]
    s_waitcnt lgkmcnt(5)
    v_rcp_f32 v47, v47
    v_mfma_f32_16x16x32_bf16 v[196:199], a[208:211], a[148:151], v[196:199]
    v_mul_f32 v46, v254, v46
    v_mul_f32 v47, v255, v47
    v_mfma_f32_16x16x32_bf16 v[204:207], a[208:211], a[152:155], v[204:207]
    v_cvt_pk_bf16_f32 v252, v44, v45
    v_cvt_pk_bf16_f32 v253, v46, v47
    v_mfma_f32_16x16x32_bf16 v[212:215], a[208:211], a[156:159], v[212:215]
    s_waitcnt lgkmcnt(4)
    v_mfma_f32_16x16x32_bf16 v[192:195], a[212:215], a[168:171], v[192:195]
    v_mfma_f32_16x16x32_bf16 v[200:203], a[212:215], a[172:175], v[200:203]
    v_mfma_f32_16x16x32_bf16 v[208:211], a[212:215], a[176:179], v[208:211]
    s_waitcnt lgkmcnt(3)
    ds_write_b64 v28, v[252:253] offset:33536
    s_waitcnt lgkmcnt(0)
    v_mfma_f32_16x16x32_bf16 v[196:199], a[216:219], a[168:171], v[196:199]
    s_barrier
    v_mfma_f32_16x16x32_bf16 v[204:207], a[216:219], a[172:175], v[204:207]
    ds_read_b128 a[228:231], v6 offset:512
    ds_read_b128 a[232:235], v7 offset:512
    v_mfma_f32_16x16x32_bf16 v[212:215], a[216:219], a[176:179], v[212:215]
    ds_read_b128 a[200:203], v6 offset:4608
    ds_read_b128 a[204:207], v7 offset:4608
    v_mfma_f32_16x16x32_bf16 v[192:195], a[220:223], a[188:191], v[192:195]
    ds_read_b128 a[208:211], v6 offset:8704
    ds_read_b128 a[212:215], v7 offset:8704
    v_mfma_f32_16x16x32_bf16 v[200:203], a[220:223], a[192:195], v[200:203]
    v_mfma_f32_16x16x32_bf16 v[208:211], a[220:223], a[196:199], v[208:211]
    v_mfma_f32_16x16x32_bf16 v[196:199], a[224:227], a[188:191], v[196:199]
    v_mfma_f32_16x16x32_bf16 v[204:207], a[224:227], a[192:195], v[204:207]
    v_mfma_f32_16x16x32_bf16 v[212:215], a[224:227], a[196:199], v[212:215]
    v_mfma_f32_16x16x16_bf16 v[216:219], v[76:77], v[24:25], 0
    v_mfma_f32_16x16x16_bf16 v[220:223], v[78:79], v[24:25], 0
    v_mfma_f32_16x16x16_bf16 v[224:227], v[80:81], v[24:25], 0
    v_mfma_f32_16x16x16_bf16 v[228:231], v[82:83], v[24:25], 0
    v_cvt_pk_bf16_f32 v192, v192, v193
    v_cvt_pk_bf16_f32 v193, v194, v195
    v_mfma_f32_16x16x16_bf16 v[232:235], v[84:85], v[24:25], 0
    v_cvt_pk_bf16_f32 v194, v196, v197
    v_cvt_pk_bf16_f32 v195, v198, v199
    v_mfma_f32_16x16x16_bf16 v[236:239], v[86:87], v[24:25], 0
    v_cvt_pk_bf16_f32 v200, v200, v201
    v_cvt_pk_bf16_f32 v201, v202, v203
    v_mfma_f32_16x16x16_bf16 v[240:243], v[88:89], v[24:25], 0
    v_cvt_pk_bf16_f32 v202, v204, v205
    v_cvt_pk_bf16_f32 v203, v206, v207
    v_mfma_f32_16x16x16_bf16 v[244:247], v[90:91], v[24:25], 0
    v_cvt_pk_bf16_f32 v208, v208, v209
    v_cvt_pk_bf16_f32 v209, v210, v211
    v_mfma_f32_16x16x16_bf16 v[248:251], v[92:93], v[24:25], 0
    s_mov_b32 s50, 1048576
    buffer_store_dwordx4 v[192:195], v23, s[28:31], s50 offen offset:128 sc1 nt
    v_mfma_f32_16x16x16_bf16 v[252:255], v[94:95], v[24:25], 0
    s_waitcnt lgkmcnt(5)
    v_cvt_pk_bf16_f32 v210, v212, v213
    v_cvt_pk_bf16_f32 v211, v214, v215
    v_mfma_f32_16x16x32_bf16 v[216:219], a[228:231], a[0:3], v[216:219]
    v_mfma_f32_16x16x32_bf16 v[224:227], a[228:231], a[4:7], v[224:227]
    s_waitcnt lgkmcnt(4)
    ds_read_b128 a[216:219], v6 offset:12800
    v_mfma_f32_16x16x32_bf16 v[220:223], a[232:235], a[0:3], v[220:223]
    v_mfma_f32_16x16x32_bf16 v[228:231], a[232:235], a[4:7], v[228:231]
    s_waitcnt lgkmcnt(4)
    ds_read_b128 a[220:223], v7 offset:12800
    v_mfma_f32_16x16x32_bf16 v[216:219], a[200:203], a[20:23], v[216:219]
    v_mfma_f32_16x16x32_bf16 v[224:227], a[200:203], a[24:27], v[224:227]
    s_waitcnt lgkmcnt(4)
    ds_read_b128 a[224:227], v6 offset:16896
    v_mfma_f32_16x16x32_bf16 v[220:223], a[204:207], a[20:23], v[220:223]
    v_mfma_f32_16x16x32_bf16 v[228:231], a[204:207], a[24:27], v[228:231]
    s_waitcnt lgkmcnt(4)
    ds_read_b128 a[228:231], v7 offset:16896
    v_mfma_f32_16x16x32_bf16 v[216:219], a[208:211], a[40:43], v[216:219]
    v_mfma_f32_16x16x32_bf16 v[224:227], a[208:211], a[44:47], v[224:227]
    s_waitcnt lgkmcnt(4)
    ds_read_b128 a[232:235], v6 offset:20992
    v_mfma_f32_16x16x32_bf16 v[220:223], a[212:215], a[40:43], v[220:223]
    v_mfma_f32_16x16x32_bf16 v[228:231], a[212:215], a[44:47], v[228:231]
    s_waitcnt lgkmcnt(4)
    ds_read_b128 a[200:203], v7 offset:20992
    v_mfma_f32_16x16x32_bf16 v[216:219], a[216:219], a[60:63], v[216:219]
    s_mov_b32 s50, 1572864
    buffer_store_dwordx4 v[200:203], v23, s[28:31], s50 offen offset:128 sc1 nt
    v_mfma_f32_16x16x32_bf16 v[224:227], a[216:219], a[64:67], v[224:227]
    s_waitcnt lgkmcnt(4)
    ds_read_b128 a[204:207], v6 offset:25088
    v_mfma_f32_16x16x32_bf16 v[220:223], a[220:223], a[60:63], v[220:223]
    v_mfma_f32_16x16x32_bf16 v[228:231], a[220:223], a[64:67], v[228:231]
    s_waitcnt lgkmcnt(4)
    ds_read_b128 a[208:211], v7 offset:25088
    v_mfma_f32_16x16x32_bf16 v[216:219], a[224:227], a[80:83], v[216:219]
    v_mfma_f32_16x16x32_bf16 v[224:227], a[224:227], a[84:87], v[224:227]
    s_waitcnt lgkmcnt(4)
    ds_read_b128 a[212:215], v6 offset:29184
    v_mfma_f32_16x16x32_bf16 v[220:223], a[228:231], a[80:83], v[220:223]
    v_mfma_f32_16x16x32_bf16 v[228:231], a[228:231], a[84:87], v[228:231]
    s_waitcnt lgkmcnt(4)
    ds_read_b128 a[216:219], v7 offset:29184
    v_mfma_f32_16x16x32_bf16 v[216:219], a[232:235], a[100:103], v[216:219]
    v_mfma_f32_16x16x32_bf16 v[224:227], a[232:235], a[104:107], v[224:227]
    s_waitcnt lgkmcnt(4)
    ds_read_b128 a[220:223], v6 offset:33280
    v_mfma_f32_16x16x32_bf16 v[220:223], a[200:203], a[100:103], v[220:223]
    v_mfma_f32_16x16x32_bf16 v[228:231], a[200:203], a[104:107], v[228:231]
    s_waitcnt lgkmcnt(4)
    ds_read_b128 a[224:227], v7 offset:33280
    v_mfma_f32_16x16x32_bf16 v[216:219], a[204:207], a[120:123], v[216:219]
    v_mfma_f32_16x16x32_bf16 v[224:227], a[204:207], a[124:127], v[224:227]
    s_waitcnt lgkmcnt(4)
    ds_read_b128 a[228:231], v6 offset:37376
    v_mfma_f32_16x16x32_bf16 v[220:223], a[208:211], a[120:123], v[220:223]
    s_mov_b32 s50, 2097152
    buffer_store_dwordx4 v[208:211], v23, s[28:31], s50 offen offset:128 sc1 nt
    v_mfma_f32_16x16x32_bf16 v[228:231], a[208:211], a[124:127], v[228:231]
    s_waitcnt lgkmcnt(4)
    ds_read_b128 a[232:235], v7 offset:37376
    v_mfma_f32_16x16x32_bf16 v[216:219], a[212:215], a[140:143], v[216:219]
    v_mfma_f32_16x16x32_bf16 v[224:227], a[212:215], a[144:147], v[224:227]
    s_waitcnt lgkmcnt(4)
    ds_read_b128 a[200:203], v6 offset:512
    v_mfma_f32_16x16x32_bf16 v[220:223], a[216:219], a[140:143], v[220:223]
    v_mfma_f32_16x16x32_bf16 v[228:231], a[216:219], a[144:147], v[228:231]
    s_waitcnt lgkmcnt(4)
    ds_read_b128 a[204:207], v7 offset:512
    v_mfma_f32_16x16x32_bf16 v[216:219], a[220:223], a[160:163], v[216:219]
    v_mfma_f32_16x16x32_bf16 v[224:227], a[220:223], a[164:167], v[224:227]
    s_waitcnt lgkmcnt(4)
    ds_read_b128 a[208:211], v6 offset:4608
    v_mfma_f32_16x16x32_bf16 v[220:223], a[224:227], a[160:163], v[220:223]
    v_mfma_f32_16x16x32_bf16 v[228:231], a[224:227], a[164:167], v[228:231]
    s_waitcnt lgkmcnt(4)
    ds_read_b128 a[212:215], v7 offset:4608
    v_mfma_f32_16x16x32_bf16 v[216:219], a[228:231], a[180:183], v[216:219]
    v_mfma_f32_16x16x32_bf16 v[224:227], a[228:231], a[184:187], v[224:227]
    s_waitcnt lgkmcnt(4)
    ds_read_b128 a[216:219], v6 offset:8704
    v_mfma_f32_16x16x32_bf16 v[220:223], a[232:235], a[180:183], v[220:223]
    v_mfma_f32_16x16x32_bf16 v[228:231], a[232:235], a[184:187], v[228:231]
    s_waitcnt lgkmcnt(4)
    ds_read_b128 a[220:223], v7 offset:8704
    v_mfma_f32_16x16x32_bf16 v[232:235], a[200:203], a[8:11], v[232:235]
    v_mfma_f32_16x16x32_bf16 v[240:243], a[200:203], a[12:15], v[240:243]
    s_waitcnt lgkmcnt(4)
    ds_read_b128 a[224:227], v6 offset:12800
    v_mfma_f32_16x16x32_bf16 v[236:239], a[204:207], a[8:11], v[236:239]
    v_mfma_f32_16x16x32_bf16 v[244:247], a[204:207], a[12:15], v[244:247]
    s_waitcnt lgkmcnt(4)
    ds_read_b128 a[228:231], v7 offset:12800
    v_cvt_pk_bf16_f32 v216, v216, v217
    v_cvt_pk_bf16_f32 v217, v218, v219
    v_mfma_f32_16x16x32_bf16 v[232:235], a[208:211], a[28:31], v[232:235]
    v_cvt_pk_bf16_f32 v218, v220, v221
    v_cvt_pk_bf16_f32 v219, v222, v223
    v_mfma_f32_16x16x32_bf16 v[240:243], a[208:211], a[32:35], v[240:243]
    s_waitcnt lgkmcnt(4)
    ds_read_b128 a[232:235], v6 offset:16896
    v_cvt_pk_bf16_f32 v224, v224, v225
    v_mfma_f32_16x16x32_bf16 v[236:239], a[212:215], a[28:31], v[236:239]
    v_cvt_pk_bf16_f32 v225, v226, v227
    v_cvt_pk_bf16_f32 v226, v228, v229
    v_mfma_f32_16x16x32_bf16 v[244:247], a[212:215], a[32:35], v[244:247]
    s_waitcnt lgkmcnt(4)
    ds_read_b128 a[200:203], v7 offset:16896
    v_cvt_pk_bf16_f32 v227, v230, v231
    v_mfma_f32_16x16x32_bf16 v[232:235], a[216:219], a[48:51], v[232:235]
    s_mov_b32 s50, 0
    buffer_store_dwordx4 v[216:219], v23, s[28:31], s50 offen offset:192 sc1 nt
    v_mfma_f32_16x16x32_bf16 v[240:243], a[216:219], a[52:55], v[240:243]
    s_waitcnt lgkmcnt(4)
    ds_read_b128 a[204:207], v6 offset:20992
    v_mfma_f32_16x16x32_bf16 v[236:239], a[220:223], a[48:51], v[236:239]
    v_mfma_f32_16x16x32_bf16 v[244:247], a[220:223], a[52:55], v[244:247]
    s_waitcnt lgkmcnt(4)
    ds_read_b128 a[208:211], v7 offset:20992
    v_mfma_f32_16x16x32_bf16 v[232:235], a[224:227], a[68:71], v[232:235]
    v_mfma_f32_16x16x32_bf16 v[240:243], a[224:227], a[72:75], v[240:243]
    s_waitcnt lgkmcnt(4)
    ds_read_b128 a[212:215], v6 offset:25088
    v_mfma_f32_16x16x32_bf16 v[236:239], a[228:231], a[68:71], v[236:239]
    v_mfma_f32_16x16x32_bf16 v[244:247], a[228:231], a[72:75], v[244:247]
    s_waitcnt lgkmcnt(4)
    ds_read_b128 a[216:219], v7 offset:25088
    v_mfma_f32_16x16x32_bf16 v[232:235], a[232:235], a[88:91], v[232:235]
    v_mfma_f32_16x16x32_bf16 v[240:243], a[232:235], a[92:95], v[240:243]
    s_waitcnt lgkmcnt(4)
    ds_read_b128 a[220:223], v6 offset:29184
    v_mfma_f32_16x16x32_bf16 v[236:239], a[200:203], a[88:91], v[236:239]
    v_mfma_f32_16x16x32_bf16 v[244:247], a[200:203], a[92:95], v[244:247]
    s_waitcnt lgkmcnt(4)
    ds_read_b128 a[224:227], v7 offset:29184
    v_mfma_f32_16x16x32_bf16 v[232:235], a[204:207], a[108:111], v[232:235]
    v_mfma_f32_16x16x32_bf16 v[240:243], a[204:207], a[112:115], v[240:243]
    s_waitcnt lgkmcnt(4)
    ds_read_b128 a[228:231], v6 offset:33280
    v_mfma_f32_16x16x32_bf16 v[236:239], a[208:211], a[108:111], v[236:239]
    s_mov_b32 s50, 524288
    buffer_store_dwordx4 v[224:227], v23, s[28:31], s50 offen offset:192 sc1 nt
    v_mfma_f32_16x16x32_bf16 v[244:247], a[208:211], a[112:115], v[244:247]
    s_waitcnt lgkmcnt(4)
    ds_read_b128 a[232:235], v7 offset:33280
    v_mfma_f32_16x16x32_bf16 v[232:235], a[212:215], a[128:131], v[232:235]
    v_mfma_f32_16x16x32_bf16 v[240:243], a[212:215], a[132:135], v[240:243]
    s_waitcnt lgkmcnt(4)
    ds_read_b128 a[200:203], v6 offset:37376
    v_mfma_f32_16x16x32_bf16 v[236:239], a[216:219], a[128:131], v[236:239]
    v_mfma_f32_16x16x32_bf16 v[244:247], a[216:219], a[132:135], v[244:247]
    s_waitcnt lgkmcnt(4)
    ds_read_b128 a[204:207], v7 offset:37376
    v_mfma_f32_16x16x32_bf16 v[232:235], a[220:223], a[148:151], v[232:235]
    v_mfma_f32_16x16x32_bf16 v[240:243], a[220:223], a[152:155], v[240:243]
    s_waitcnt lgkmcnt(4)
    ds_read_b128 a[208:211], v6 offset:512
    v_mfma_f32_16x16x32_bf16 v[236:239], a[224:227], a[148:151], v[236:239]
    v_mfma_f32_16x16x32_bf16 v[244:247], a[224:227], a[152:155], v[244:247]
    s_waitcnt lgkmcnt(4)
    ds_read_b128 a[212:215], v7 offset:512
    v_mfma_f32_16x16x32_bf16 v[232:235], a[228:231], a[168:171], v[232:235]
    v_mfma_f32_16x16x32_bf16 v[240:243], a[228:231], a[172:175], v[240:243]
    s_waitcnt lgkmcnt(4)
    ds_read_b128 a[216:219], v6 offset:4608
    v_mfma_f32_16x16x32_bf16 v[236:239], a[232:235], a[168:171], v[236:239]
    v_mfma_f32_16x16x32_bf16 v[244:247], a[232:235], a[172:175], v[244:247]
    s_waitcnt lgkmcnt(4)
    ds_read_b128 a[220:223], v7 offset:4608
    v_mfma_f32_16x16x32_bf16 v[232:235], a[200:203], a[188:191], v[232:235]
    v_mfma_f32_16x16x32_bf16 v[240:243], a[200:203], a[192:195], v[240:243]
    s_waitcnt lgkmcnt(4)
    ds_read_b128 a[224:227], v6 offset:8704
    v_mfma_f32_16x16x32_bf16 v[236:239], a[204:207], a[188:191], v[236:239]
    v_mfma_f32_16x16x32_bf16 v[244:247], a[204:207], a[192:195], v[244:247]
    s_waitcnt lgkmcnt(4)
    ds_read_b128 a[228:231], v7 offset:8704
    v_mfma_f32_16x16x32_bf16 v[248:251], a[208:211], a[16:19], v[248:251]
    s_waitcnt lgkmcnt(4)
    v_mfma_f32_16x16x32_bf16 v[252:255], a[212:215], a[16:19], v[252:255]
    s_waitcnt lgkmcnt(3)
    ds_read_b128 a[232:235], v6 offset:12800
    v_mfma_f32_16x16x32_bf16 v[248:251], a[216:219], a[36:39], v[248:251]
    s_waitcnt lgkmcnt(3)
    ds_read_b128 a[200:203], v7 offset:12800
    v_mfma_f32_16x16x32_bf16 v[252:255], a[220:223], a[36:39], v[252:255]
    s_waitcnt lgkmcnt(3)
    ds_read_b128 a[204:207], v6 offset:16896
    v_cvt_pk_bf16_f32 v232, v232, v233
    v_cvt_pk_bf16_f32 v233, v234, v235
    v_cvt_pk_bf16_f32 v234, v236, v237
    v_mfma_f32_16x16x32_bf16 v[248:251], a[224:227], a[56:59], v[248:251]
    s_waitcnt lgkmcnt(3)
    ds_read_b128 a[208:211], v7 offset:16896
    v_cvt_pk_bf16_f32 v235, v238, v239
    v_mfma_f32_16x16x32_bf16 v[252:255], a[228:231], a[56:59], v[252:255]
    s_waitcnt lgkmcnt(3)
    ds_read_b128 a[212:215], v6 offset:20992
    v_mfma_f32_16x16x32_bf16 v[248:251], a[232:235], a[76:79], v[248:251]
    s_waitcnt lgkmcnt(3)
    ds_read_b128 a[216:219], v7 offset:20992
    v_mfma_f32_16x16x32_bf16 v[252:255], a[200:203], a[76:79], v[252:255]
    s_waitcnt lgkmcnt(3)
    ds_read_b128 a[220:223], v6 offset:25088
    v_mfma_f32_16x16x32_bf16 v[248:251], a[204:207], a[96:99], v[248:251]
    s_waitcnt lgkmcnt(3)
    s_mov_b32 s50, 1048576
    ds_read_b128 a[224:227], v7 offset:25088
    buffer_store_dwordx4 v[232:235], v23, s[28:31], s50 offen offset:192 sc1 nt
    v_mfma_f32_16x16x32_bf16 v[252:255], a[208:211], a[96:99], v[252:255]
    s_waitcnt lgkmcnt(3)
    ds_read_b128 a[228:231], v6 offset:29184
    v_mfma_f32_16x16x32_bf16 v[248:251], a[212:215], a[116:119], v[248:251]
    s_waitcnt lgkmcnt(3)
    ds_read_b128 a[232:235], v7 offset:29184
    v_mfma_f32_16x16x32_bf16 v[252:255], a[216:219], a[116:119], v[252:255]
    s_waitcnt lgkmcnt(3)
    ds_read_b128 a[200:203], v6 offset:33280
    v_mfma_f32_16x16x32_bf16 v[248:251], a[220:223], a[136:139], v[248:251]
    s_waitcnt lgkmcnt(3)
    ds_read_b128 a[204:207], v7 offset:33280
    v_mfma_f32_16x16x32_bf16 v[252:255], a[224:227], a[136:139], v[252:255]
    s_waitcnt lgkmcnt(3)
    ds_read_b128 a[208:211], v6 offset:37376
    v_mfma_f32_16x16x32_bf16 v[248:251], a[228:231], a[156:159], v[248:251]
    s_waitcnt lgkmcnt(3)
    ds_read_b128 a[212:215], v7 offset:37376
    v_mfma_f32_16x16x32_bf16 v[252:255], a[232:235], a[156:159], v[252:255]
    s_waitcnt lgkmcnt(3)
    v_mfma_f32_16x16x32_bf16 v[248:251], a[200:203], a[176:179], v[248:251]
    s_waitcnt lgkmcnt(2)
    v_mfma_f32_16x16x32_bf16 v[252:255], a[204:207], a[176:179], v[252:255]
    s_waitcnt lgkmcnt(1)
    v_mfma_f32_16x16x32_bf16 v[248:251], a[208:211], a[196:199], v[248:251]
    s_waitcnt lgkmcnt(0)
    v_mfma_f32_16x16x32_bf16 v[252:255], a[212:215], a[196:199], v[252:255]
    s_nop 7
    v_cvt_pk_bf16_f32 v240, v240, v241
    v_cvt_pk_bf16_f32 v241, v242, v243
    v_cvt_pk_bf16_f32 v242, v244, v245
    v_cvt_pk_bf16_f32 v243, v246, v247
    s_mov_b32 s50, 1572864
    buffer_store_dwordx4 v[240:243], v23, s[28:31], s50 offen offset:192 sc1 nt
    v_cvt_pk_bf16_f32 v248, v248, v249
    v_cvt_pk_bf16_f32 v249, v250, v251
    v_cvt_pk_bf16_f32 v250, v252, v253
    v_cvt_pk_bf16_f32 v251, v254, v255
    s_mov_b32 s50, 2097152
    buffer_store_dwordx4 v[248:251], v23, s[28:31], s50 offen offset:192 sc1 nt
L_end:
    s_endpgm
L_code_end:
.section .rodata,"a"
.p2align 6
.amdhsa_kernel standalone__edm_precond__diffusion_kernel
  .amdhsa_next_free_vgpr 512
  .amdhsa_next_free_sgpr 102
  .amdhsa_accum_offset 256
  .amdhsa_group_segment_fixed_size 0
  .amdhsa_kernarg_size 64
  .amdhsa_user_sgpr_count 2
  .amdhsa_user_sgpr_kernarg_segment_ptr 1
  .amdhsa_system_sgpr_workgroup_id_x 1
.end_amdhsa_kernel
```
